```python
import torch

def _softmax(x, axis=-1):
    return torch.softmax(x, dim=axis)
def _gelu(x):
    return torch.nn.functional.gelu(x, approximate="tanh")
def _silu(x):
    return torch.nn.functional.silu(x)
def _sigmoid(x):
    return torch.sigmoid(x)
def _layernorm(x, axis=-1, eps=1e-5):
    m = x.mean(dim=axis, keepdim=True)
    v = x.var(dim=axis, keepdim=True, unbiased=False)
    return (x - m) / torch.sqrt(v + eps)
def _scatter_add(tgt, idx, src, axis=0):
    return tgt.clone().index_add_(axis, idx, src)
def _segment_sum(src, seg, n):
    out = torch.zeros((n,) + src.shape[1:], dtype=src.dtype)
    return out.index_add_(0, seg, src)
def _pad(x, pw):
    flat = tuple(v for pair in reversed(pw) for v in pair)
    return torch.nn.functional.pad(x, flat)

kernel_name = 'sequential_preLN__ssm_conv_s4d__glu_gated_swiglu__prompt'

def setup_inputs():

    _w = (lambda a: (lambda t: t.to(torch.bfloat16) if t.is_floating_point() else t)(torch.as_tensor(a)))
    def _A_setup():
        Bsz, L, D, N = 1, 2048, 448, 256
        return {
            "u": _w((lambda *s: torch.randn(*s, dtype=torch.bfloat16) * 0.05)(Bsz, L, D)),
            "log_A_real": _w((lambda *s: torch.randn(*s, dtype=torch.bfloat16) * 6.4)(D, N) * 0.5),
            "A_imag": _w((lambda *s: torch.randn(*s, dtype=torch.bfloat16) * 0.05)(D, N) * 3.14),
            "C_real": _w((lambda *s: torch.randn(*s, dtype=torch.bfloat16) * 0.05)(D, N) / N ** 0.5),
            "C_imag": _w((lambda *s: torch.randn(*s, dtype=torch.bfloat16) * 0.05)(D, N) / N ** 0.5),
            "log_dt": _w((lambda *s: torch.randn(*s, dtype=torch.bfloat16) * 0.05)(D) * 0.5 - 4.0),
            "D_skip": _w((lambda *s: torch.randn(*s, dtype=torch.bfloat16) * 0.05)(D)),
        }
    _A_in = _A_setup()

    def _B_setup():
        B, S, D, F = 1, 2048, 448, 1792
        return {
            "x": _w((lambda *s: torch.randn(*s, dtype=torch.bfloat16) * 0.05)(B, S, D)),
            "w1": _w((lambda *s: torch.randn(*s, dtype=torch.bfloat16) * 0.4)(D, F) * (2.0 / D) ** 0.5),
            "w3": _w((lambda *s: torch.randn(*s, dtype=torch.bfloat16) * 0.4)(D, F) * (2.0 / D) ** 0.5),
            "w2": _w((lambda *s: torch.randn(*s, dtype=torch.bfloat16) * 0.4)(F, D) * (2.0 / F) ** 0.5),
        }
    _B_in = _B_setup()

    return {
        "A_u": _A_in["u"],
        "A_log_A_real": _A_in["log_A_real"],
        "A_A_imag": _A_in["A_imag"],
        "A_C_real": _A_in["C_real"],
        "A_C_imag": _A_in["C_imag"],
        "A_log_dt": _A_in["log_dt"],
        "A_D_skip": _A_in["D_skip"],
        "B_x": _B_in["x"],
        "B_w1": _B_in["w1"],
        "B_w3": _B_in["w3"],
        "B_w2": _B_in["w2"],
    }

def reference(A_u, A_log_A_real, A_A_imag, A_C_real, A_C_imag, A_log_dt, A_D_skip, B_x, B_w1, B_w3, B_w2):
    def _A_ref(u, log_A_real, A_imag, C_real, C_imag, log_dt, D_skip):
        L = u.shape[1]
        dt = torch.exp(log_dt)
        A = -torch.exp(log_A_real) + 1j * A_imag
        C = (C_real + 1j * C_imag) * dt[:, None]
        pos = (lambda x, dt: x.to(dt))(torch.arange(L), log_dt.dtype)
        P = torch.exp((A * dt[:, None])[:, :, None] * pos[None, None, :])
        K = 2.0 * torch.einsum("dn,dnl->dl", C, P).real
        L2 = 2 * L
        u_t = (lambda x, *d: x.permute(*d))(u, 0, 2, 1)
        Kf = (lambda x, *a, **k: torch.fft.rfft(x.float(), *a, **k))(K, L2)
        Uf = (lambda x, *a, **k: torch.fft.rfft(x.float(), *a, **k))(u_t, L2)
        y = (lambda x, *a, **k: torch.fft.irfft(x, *a, **k).to(torch.bfloat16))(Uf * Kf[None, :, :], L2)[:, :, :L]
        y = (lambda x, *d: x.permute(*d))(y, 0, 2, 1)
        return y + u * D_skip[None, None, :]

    def _B_ref(x, w1, w3, w2):
        gate = torch.einsum("bsd,df->bsf", x, w1)
        up = torch.einsum("bsd,df->bsf", x, w3)
        h = _silu(gate) * up
        out = torch.einsum("bsf,fd->bsd", h, w2)
        return out

    x = A_u
    h = x + _A_ref(_layernorm(x, axis=-1), A_log_A_real, A_A_imag, A_C_real, A_C_imag, A_log_dt, A_D_skip)
    h2 = h + _B_ref(_layernorm(h, axis=-1), B_w1, B_w3, B_w2)
    return h2
```

```asm
; @launch grid=(256,1,1) block=(256,1,1) lds=155648
.amdgcn_target "amdgcn-amd-amdhsa--gfx950"
.text
.globl sequential_preLN__ssm_conv_s4d__glu_gated_swiglu__prompt_kernel
.p2align 8
.type sequential_preLN__ssm_conv_s4d__glu_gated_swiglu__prompt_kernel,@function
sequential_preLN__ssm_conv_s4d__glu_gated_swiglu__prompt_kernel:
    s_cmp_ge_u32 s2, 256
    s_cbranch_scc1 sequential_preLN__ssm_conv_s4d__glu_gated_swiglu__prompt_kernel_done
    s_load_dwordx16 s[4:19], s[0:1], 0
    s_load_dwordx8 s[20:27], s[0:1], 64
    s_load_dwordx4 s[28:31], s[0:1], 96
    v_lshrrev_b32 v1, 6, v0
    s_nop 0
    v_readfirstlane_b32 s3, v1
    v_and_b32 v1, 63, v0
    v_lshlrev_b32 v2, 4, v1
    v_lshrrev_b32 v3, 5, v1
    s_nop 0
    s_cmp_lt_u32 s3, 2
    s_cbranch_scc1 sequential_preLN__ssm_conv_s4d__glu_gated_swiglu__prompt_kernel_pf1
    s_getpc_b64 s[60:61]
sequential_preLN__ssm_conv_s4d__glu_gated_swiglu__prompt_kernel_pc:
    s_lshr_b32 s62, s2, 3
    s_lshl_b32 s62, s62, 1
    s_and_b32 s63, s3, 1
    s_add_u32 s62, s62, s63
    s_mul_i32 s62, s62, 640
    s_min_u32 s62, s62, sequential_preLN__ssm_conv_s4d__glu_gated_swiglu__prompt_kernel_end-sequential_preLN__ssm_conv_s4d__glu_gated_swiglu__prompt_kernel_pc-1024
    s_add_u32 s60, s60, s62
    s_addc_u32 s61, s61, 0
    global_load_dwordx4 v[8:11], v2, s[60:61]
sequential_preLN__ssm_conv_s4d__glu_gated_swiglu__prompt_kernel_pf1:
    s_waitcnt lgkmcnt(0)
    s_mov_b32 s32, s30
    s_mov_b32 s33, s31
    s_mov_b32 s34, 22069376
    s_mov_b32 s35, 0x20000
    v_mov_b32 v4, 17874944
    global_load_dword v239, v4, s[30:31] sc1
    s_mov_b32 s36, s4
    s_mov_b32 s37, s5
    s_mov_b32 s38, 1835008
    s_mov_b32 s39, 0x20000
    s_lshl_b32 s52, s2, 3
    s_lshl_b32 s53, s3, 1
    s_add_u32 s53, s52, s53
    s_mul_i32 s54, s53, 896
    v_mov_b32 v96, 0
    v_mov_b32 v97, 0
    v_mov_b32 v98, 0
    v_mov_b32 v99, 0
    v_mov_b32 v100, 0
    v_mov_b32 v101, 0
    v_mov_b32 v102, 0
    v_mov_b32_e64 v103, 0
    s_mov_b32 exec_hi, 0x00ffffff
    buffer_load_dwordx4 v[96:99], v2, s[36:39], s54 offen offset:0
    buffer_load_dwordx4 v[100:103], v2, s[36:39], s54 offen offset:896
    s_mov_b32 exec_hi, -1
    s_cmp_lg_u32 s3, 1
    s_cbranch_scc1 sequential_preLN__ssm_conv_s4d__glu_gated_swiglu__prompt_kernel_tch3
    v_lshlrev_b32 v4, 21, v1
    s_mov_b32 exec_lo, 0x1ff
    s_mov_b32 exec_hi, 0
    buffer_load_dword v12, v4, s[32:35], 0 offen offset:2048
    s_mov_b64 exec, -1
sequential_preLN__ssm_conv_s4d__glu_gated_swiglu__prompt_kernel_tch3:
    s_cmp_ge_u32 s2, 224
    s_cbranch_scc1 sequential_preLN__ssm_conv_s4d__glu_gated_swiglu__prompt_kernel_helper2
    s_and_b32 s52, s2, 7
    s_mul_i32 s70, s52, 28
    s_lshr_b32 s52, s2, 3
    s_add_u32 s70, s70, s52
    s_mov_b32 s36, s6
    s_mov_b32 s37, s7
    s_mov_b32 s38, 229376
    s_mov_b32 s39, 0x20000
    s_mov_b32 s40, s8
    s_mov_b32 s41, s9
    s_mov_b32 s42, 229376
    s_mov_b32 s43, 0x20000
    s_mov_b32 s44, s10
    s_mov_b32 s45, s11
    s_mov_b32 s46, 229376
    s_mov_b32 s47, 0x20000
    s_mov_b32 s48, s12
    s_mov_b32 s49, s13
    s_mov_b32 s50, 229376
    s_mov_b32 s51, 0x20000
    s_lshl_b32 s52, s70, 10
    v_lshlrev_b32_e64 v4, 1, v0
    buffer_load_ushort v240, v4, s[36:39], s52 offen offset:0
    buffer_load_ushort v241, v4, s[40:43], s52 offen offset:0
    buffer_load_ushort v242, v4, s[44:47], s52 offen offset:0
    buffer_load_ushort v243, v4, s[48:51], s52 offen offset:0
    buffer_load_ushort v244, v4, s[36:39], s52 offen offset:512
    buffer_load_ushort v245, v4, s[40:43], s52 offen offset:512
    buffer_load_ushort v246, v4, s[44:47], s52 offen offset:512
    buffer_load_ushort v247, v4, s[48:51], s52 offen offset:512
    s_mov_b32 s36, s14
    s_mov_b32 s37, s15
    s_mov_b32 s38, 896
    s_mov_b32 s39, 0x20000
    s_mov_b32 s40, s16
    s_mov_b32 s41, s17
    s_mov_b32 s42, 896
    s_mov_b32 s43, 0x20000
    s_lshl_b32 s52, s70, 2
    v_mov_b32 v4, 0
    buffer_load_dword v248, v4, s[36:39], s52 offen
    buffer_load_dword v249, v4, s[40:43], s52 offen
    v_mov_b32 v224, 0
    v_mov_b32 v225, 0
    v_mov_b32 v226, 0
    v_mov_b32 v227, 0
    v_lshlrev_b32_e64 v6, 4, v0
    v_cmp_gt_u32 vcc, 160, v0
    s_nop 3
    s_and_saveexec_b64 s[62:63], vcc
    ds_write_b128 v6, v[224:227] offset:33408
    ds_write_b128 v6, v[224:227] offset:41088
    s_mov_b64 exec, s[62:63]
    v_and_b32 v6, 3, v0
    v_lshlrev_b32_e64 v6, 4, v6
    v_bfe_u32 v7, v0, 2, 2
    v_mul_u32_u24 v7, 4160, v7
    v_add_u32_e64 v6, v6, v7
    v_bfe_u32 v7, v0, 4, 1
    v_mul_u32_u24 v7, 16672, v7
    v_add_u32 v6, v6, v7
    v_cmp_gt_u32 vcc, 32, v0
    s_nop 3
    s_and_saveexec_b64 s[62:63], vcc
    ds_write_b128 v6, v[224:227] offset:64
    s_mov_b64 exec, s[62:63]
    s_mul_i32 s77, s3, 24576
    s_add_u32 s77, s77, 49152
    v_and_b32 v6, 7, v1
    v_lshlrev_b32 v7, 7, v1
    v_add_u32 v7, s77, v7
    v_xor_b32_e64 v48, 0, v6
    v_lshl_add_u32 v48, v48, 4, v7
    v_xor_b32_e64 v49, 1, v6
    v_lshl_add_u32 v49, v49, 4, v7
    v_xor_b32_e64 v50, 2, v6
    v_lshl_add_u32 v50, v50, 4, v7
    v_xor_b32_e64 v51, 3, v6
    v_lshl_add_u32 v51, v51, 4, v7
    v_xor_b32_e64 v52, 4, v6
    v_lshl_add_u32 v52, v52, 4, v7
    v_xor_b32_e64 v53, 5, v6
    v_lshl_add_u32 v53, v53, 4, v7
    v_xor_b32_e64 v54, 6, v6
    v_lshl_add_u32 v54, v54, 4, v7
    v_xor_b32_e64 v55, 7, v6
    v_lshl_add_u32 v55, v55, 4, v7
    v_and_b32 v6, 15, v1
    v_lshrrev_b32 v6, 2, v6
    v_lshrrev_b32_e64 v7, 1, v6
    v_lshl_add_u32 v7, v3, 2, v7
    v_and_b32 v6, 1, v6
    v_lshlrev_b32 v6, 2, v6
    v_bfe_u32 v228, v1, 4, 1
    v_lshl_add_u32 v6, v228, 1, v6
    v_bfe_u32 v228, v1, 1, 1
    v_add_u32 v6, v6, v228
    v_and_b32 v228, 1, v1
    v_lshlrev_b32 v228, 3, v228
    v_add_u32 v228, s77, v228
    v_add_u32 v229, 0, v7
    v_xor_b32 v230, v6, v229
    v_lshl_add_u32 v56, v230, 4, v228
    v_lshl_add_u32 v56, v229, 7, v56
    v_add_u32 v229, 2, v7
    v_xor_b32 v230, v6, v229
    v_lshl_add_u32 v57, v230, 4, v228
    v_lshl_add_u32 v57, v229, 7, v57
    s_mul_i32 s53, s3, 1920
    s_add_u32 s53, s53, 147520
    v_add_u32_e64 v4, s53, v2
    s_mov_b32 exec_hi, 0x00ffffff
    s_waitcnt vmcnt(11)
    ds_write_b128 v4, v[96:99] offset:0
    s_waitcnt vmcnt(10)
    ds_write_b128 v4, v[100:103] offset:960
    s_mov_b32 exec_hi, -1
    v_and_b32 v5, 15, v1
    v_lshrrev_b32_e64 v5, 2, v5
    v_mul_u32_u24 v5, 960, v5
    v_lshrrev_b32_e64 v6, 4, v1
    v_lshl_add_u32 v5, v6, 5, v5
    v_and_b32_e64 v6, 3, v1
    v_lshl_add_u32 v5, v6, 3, v5
    s_lshl_b32 s53, s3, 8
    s_add_u32 s53, s53, 147520
    v_add_u32 v5, s53, v5
    s_waitcnt lgkmcnt(0)
    s_barrier
    ds_read_b64_tr_b16 v[104:105], v5 offset:0
    ds_read_b64_tr_b16 v[106:107], v5 offset:3840
    ds_read_b64_tr_b16 v[108:109], v5 offset:128
    ds_read_b64_tr_b16 v[110:111], v5 offset:3968
    s_mul_i32 s53, s2, 7168
    s_lshl_b32 s54, s3, 11
    s_add_u32 s53, s53, s54
    s_add_u32 s53, s53, 0
    s_waitcnt lgkmcnt(2)
    buffer_store_dwordx4 v[104:107], v2, s[32:35], s53 offen sc1
    s_waitcnt lgkmcnt(0)
    s_cmp_eq_u32 s3, 3
    s_cbranch_scc1 sequential_preLN__ssm_conv_s4d__glu_gated_swiglu__prompt_kernel_xt34
    buffer_store_dwordx4 v[108:111], v2, s[32:35], s53 offen offset:1024 sc1
sequential_preLN__ssm_conv_s4d__glu_gated_swiglu__prompt_kernel_xt34:
    v_lshlrev_b32 v104, 16, v96
    v_and_b32 v105, 0xffff0000, v96
    v_lshlrev_b32_e64 v106, 16, v97
    v_and_b32 v107, 0xffff0000, v97
    v_lshlrev_b32_e64 v108, 16, v98
    v_and_b32 v109, 0xffff0000, v98
    v_lshlrev_b32_e64 v110, 16, v99
    v_and_b32 v111, 0xffff0000, v99
    v_lshlrev_b32_e64 v112, 16, v100
    v_and_b32 v113, 0xffff0000, v100
    v_lshlrev_b32_e64 v114, 16, v101
    v_and_b32 v115, 0xffff0000, v101
    v_lshlrev_b32_e64 v116, 16, v102
    v_and_b32 v117, 0xffff0000, v102
    v_lshlrev_b32_e64 v118, 16, v103
    v_and_b32 v119, 0xffff0000, v103
    v_pk_add_f32 v[76:77], v[104:105], v[106:107]
    v_pk_mul_f32 v[78:79], v[104:105], v[104:105]
    v_pk_add_f32 v[80:81], v[112:113], v[114:115]
    v_pk_mul_f32 v[82:83], v[112:113], v[112:113]
    v_pk_fma_f32 v[78:79], v[106:107], v[106:107], v[78:79]
    v_pk_fma_f32 v[82:83], v[114:115], v[114:115], v[82:83]
    v_pk_add_f32 v[76:77], v[76:77], v[108:109]
    v_pk_fma_f32 v[78:79], v[108:109], v[108:109], v[78:79]
    v_pk_add_f32 v[80:81], v[80:81], v[116:117]
    v_pk_fma_f32 v[82:83], v[116:117], v[116:117], v[82:83]
    v_pk_add_f32 v[76:77], v[76:77], v[110:111]
    v_pk_fma_f32 v[78:79], v[110:111], v[110:111], v[78:79]
    v_pk_add_f32 v[80:81], v[80:81], v[118:119]
    v_pk_fma_f32 v[82:83], v[118:119], v[118:119], v[82:83]
    v_add_f32 v76, v76, v77
    v_add_f32 v78, v78, v79
    v_add_f32 v80, v80, v81
    v_add_f32 v82, v82, v83
    v_add_f32_dpp v76, v76, v76 row_shr:1 row_mask:0xf bank_mask:0xf bound_ctrl:0
    v_add_f32_dpp v80, v80, v80 row_shr:1 row_mask:0xf bank_mask:0xf bound_ctrl:0
    v_add_f32_dpp v78, v78, v78 row_shr:1 row_mask:0xf bank_mask:0xf bound_ctrl:0
    v_add_f32_dpp v82, v82, v82 row_shr:1 row_mask:0xf bank_mask:0xf bound_ctrl:0
    v_add_f32_dpp v76, v76, v76 row_shr:2 row_mask:0xf bank_mask:0xf bound_ctrl:0
    v_add_f32_dpp v80, v80, v80 row_shr:2 row_mask:0xf bank_mask:0xf bound_ctrl:0
    v_add_f32_dpp v78, v78, v78 row_shr:2 row_mask:0xf bank_mask:0xf bound_ctrl:0
    v_add_f32_dpp v82, v82, v82 row_shr:2 row_mask:0xf bank_mask:0xf bound_ctrl:0
    v_add_f32_dpp v76, v76, v76 row_shr:4 row_mask:0xf bank_mask:0xf bound_ctrl:0
    v_add_f32_dpp v80, v80, v80 row_shr:4 row_mask:0xf bank_mask:0xf bound_ctrl:0
    v_add_f32_dpp v78, v78, v78 row_shr:4 row_mask:0xf bank_mask:0xf bound_ctrl:0
    v_add_f32_dpp v82, v82, v82 row_shr:4 row_mask:0xf bank_mask:0xf bound_ctrl:0
    v_add_f32_dpp v76, v76, v76 row_shr:8 row_mask:0xf bank_mask:0xf bound_ctrl:0
    v_add_f32_dpp v80, v80, v80 row_shr:8 row_mask:0xf bank_mask:0xf bound_ctrl:0
    v_add_f32_dpp v78, v78, v78 row_shr:8 row_mask:0xf bank_mask:0xf bound_ctrl:0
    v_add_f32_dpp v82, v82, v82 row_shr:8 row_mask:0xf bank_mask:0xf bound_ctrl:0
    v_add_f32_dpp v76, v76, v76 row_bcast:15 row_mask:0xa bank_mask:0xf
    v_add_f32_dpp v80, v80, v80 row_bcast:15 row_mask:0xa bank_mask:0xf
    v_add_f32_dpp v78, v78, v78 row_bcast:15 row_mask:0xa bank_mask:0xf
    v_add_f32_dpp v82, v82, v82 row_bcast:15 row_mask:0xa bank_mask:0xf
    v_add_f32_dpp v76, v76, v76 row_bcast:31 row_mask:0xc bank_mask:0xf
    v_add_f32_dpp v80, v80, v80 row_bcast:31 row_mask:0xc bank_mask:0xf
    v_add_f32_dpp v78, v78, v78 row_bcast:31 row_mask:0xc bank_mask:0xf
    v_add_f32_dpp v82, v82, v82 row_bcast:31 row_mask:0xc bank_mask:0xf
    v_mul_f32 v76, 0x3b124925, v76
    v_mul_f32 v78, 0x3b124925, v78
    v_mul_f32 v80, 0x3b124925, v80
    v_mul_f32 v82, 0x3b124925, v82
    v_fma_f32 v78, -v76, v76, v78
    v_fma_f32 v82, -v80, v80, v82
    v_cvt_pk_bf16_f32 v77, v76, v78
    v_cvt_pk_bf16_f32 v81, v80, v82
    v_and_b32 v78, 0xffff0000, v77
    v_and_b32 v82, 0xffff0000, v81
    v_add_f32 v78, 0x3727c5ac, v78
    v_add_f32 v82, 0x3727c5ac, v82
    v_cvt_pk_bf16_f32 v78, v78, v78
    v_cvt_pk_bf16_f32 v82, v82, v82
    v_and_b32 v78, 0xffff0000, v78
    v_and_b32 v82, 0xffff0000, v82
    v_sqrt_f32 v78, v78
    v_sqrt_f32 v82, v82
    s_mov_b32 s52, 0x9E3779B1
    v_mul_lo_u32 v239, v239, s52
    v_add_u32 v239, 0x7F4A7C15, v239
    v_max_u32 v239, 1, v239
    s_nop 0
    v_readfirstlane_b32 s71, v239
    v_cvt_pk_bf16_f32 v78, v78, v78
    v_cvt_pk_bf16_f32 v82, v82, v82
    s_mov_b32 s53, 0xffff
    v_bfi_b32 v84, s53, v77, v78
    v_mov_b32 v85, s71
    v_bfi_b32 v86, s53, v81, v82
    v_mov_b32 v87, s71
    s_lshl_b32 s53, s3, 4
    s_add_u32 s53, s53, 147456
    v_mov_b32 v4, s53
    s_mov_b32 exec_lo, 0
    s_mov_b32 exec_hi, 0x80000000
    ds_write_b128 v4, v[84:87]
    s_mov_b64 exec, -1
    s_waitcnt vmcnt(2)
    v_lshlrev_b32_e64 v224, 16, v248
    v_mul_f32 v224, 0x3fb8aa3b, v224
    v_lshlrev_b32 v225, 16, v240
    v_lshlrev_b32 v226, 16, v241
    v_lshlrev_b32 v227, 16, v242
    v_lshlrev_b32 v228, 16, v243
    v_exp_f32_e64 v224, v224
    v_mul_f32 v225, 0x3fb8aa3b, v225
    v_exp_f32_e64 v225, v225
    v_cvt_pk_bf16_f32 v224, v224, v224
    v_and_b32 v224, 0xffff0000, v224
    v_cvt_pk_bf16_f32 v225, v225, v225
    v_and_b32 v225, 0xffff0000, v225
    v_mul_f32 v226, v226, v224
    v_mul_f32 v225, v225, v224
    v_mul_f32 v218, v227, v224
    v_mul_f32 v219, v228, v224
    v_mul_f32 v225, 0xbfb8aa3b, v225
    v_mul_f32 v226, 0x3e22f983, v226
    v_pk_add_f32 v[218:219], v[218:219], v[218:219]
    v_mul_f32 v233, 0x43800000, v225
    v_mul_f32 v234, 0x43800000, v226
    v_exp_f32 v229, v225
    v_fract_f32 v230, v226
    v_exp_f32 v233, v233
    v_fract_f32 v234, v234
    v_cos_f32 v231, v230
    v_sin_f32 v232, v230
    v_cos_f32 v235, v234
    v_sin_f32 v236, v234
    v_mul_f32 v208, v229, v231
    v_mul_f32 v209, v229, v232
    v_mul_f32 v216, v233, v235
    v_mul_f32_e64 v217, v233, v236
    v_pk_mul_f32 v[210:211], v[208:209], v[208:209] op_sel:[0,0] op_sel_hi:[0,1]
    v_pk_fma_f32 v[210:211], v[208:209], v[208:209], v[210:211] op_sel:[1,1,0] op_sel_hi:[1,0,1] neg_lo:[1,0,0]
    v_pk_mul_f32 v[212:213], v[210:211], v[210:211] op_sel:[0,0] op_sel_hi:[0,1]
    v_pk_fma_f32 v[212:213], v[210:211], v[210:211], v[212:213] op_sel:[1,1,0] op_sel_hi:[1,0,1] neg_lo:[1,0,0]
    v_pk_mul_f32 v[214:215], v[212:213], v[212:213] op_sel:[0,0] op_sel_hi:[0,1]
    v_pk_fma_f32 v[214:215], v[212:213], v[212:213], v[214:215] op_sel:[1,1,0] op_sel_hi:[1,0,1] neg_lo:[1,0,0]
    v_pk_mul_f32 v[96:97], v[218:219], v[208:209] op_sel:[0,0] op_sel_hi:[0,1]
    v_pk_fma_f32 v[96:97], v[218:219], v[208:209], v[96:97] op_sel:[1,1,0] op_sel_hi:[1,0,1] neg_lo:[1,0,0]
    v_pk_mul_f32 v[98:99], v[96:97], v[208:209] op_sel:[0,0] op_sel_hi:[0,1]
    v_pk_fma_f32 v[98:99], v[96:97], v[208:209], v[98:99] op_sel:[1,1,0] op_sel_hi:[1,0,1] neg_lo:[1,0,0]
    v_pk_mul_f32 v[100:101], v[98:99], v[208:209] op_sel:[0,0] op_sel_hi:[0,1]
    v_pk_fma_f32 v[100:101], v[98:99], v[208:209], v[100:101] op_sel:[1,1,0] op_sel_hi:[1,0,1] neg_lo:[1,0,0]
    v_pk_mul_f32 v[102:103], v[100:101], v[208:209] op_sel:[0,0] op_sel_hi:[0,1]
    v_pk_fma_f32 v[102:103], v[100:101], v[208:209], v[102:103] op_sel:[1,1,0] op_sel_hi:[1,0,1] neg_lo:[1,0,0]
    v_pk_mul_f32 v[104:105], v[102:103], v[208:209] op_sel:[0,0] op_sel_hi:[0,1]
    v_pk_fma_f32 v[104:105], v[102:103], v[208:209], v[104:105] op_sel:[1,1,0] op_sel_hi:[1,0,1] neg_lo:[1,0,0]
    v_pk_mul_f32 v[106:107], v[104:105], v[208:209] op_sel:[0,0] op_sel_hi:[0,1]
    v_pk_fma_f32 v[106:107], v[104:105], v[208:209], v[106:107] op_sel:[1,1,0] op_sel_hi:[1,0,1] neg_lo:[1,0,0]
    v_pk_mul_f32 v[108:109], v[106:107], v[208:209] op_sel:[0,0] op_sel_hi:[0,1]
    v_pk_fma_f32 v[108:109], v[106:107], v[208:209], v[108:109] op_sel:[1,1,0] op_sel_hi:[1,0,1] neg_lo:[1,0,0]
    v_cvt_pk_bf16_f32 v160, v218, v96
    v_cvt_pk_bf16_f32 v161, v98, v100
    v_cvt_pk_bf16_f32 v162, v102, v104
    v_cvt_pk_bf16_f32 v163, v106, v108
    v_cvt_pk_bf16_f32 v164, -v219, -v97
    ds_write_b128 v48, v[160:163] offset:0
    v_cvt_pk_bf16_f32 v165, -v99, -v101
    v_cvt_pk_bf16_f32 v166, -v103, -v105
    v_cvt_pk_bf16_f32 v167, -v107, -v109
    v_pk_mul_f32 v[110:111], v[218:219], v[216:217] op_sel:[0,0] op_sel_hi:[0,1]
    v_pk_fma_f32 v[110:111], v[218:219], v[216:217], v[110:111] op_sel:[1,1,0] op_sel_hi:[1,0,1] neg_lo:[1,0,0]
    v_pk_mul_f32 v[112:113], v[110:111], v[210:211] op_sel:[0,0] op_sel_hi:[0,1]
    v_pk_fma_f32 v[112:113], v[110:111], v[210:211], v[112:113] op_sel:[1,1,0] op_sel_hi:[1,0,1] neg_lo:[1,0,0]
    v_pk_mul_f32 v[114:115], v[110:111], v[212:213] op_sel:[0,0] op_sel_hi:[0,1]
    v_pk_fma_f32 v[114:115], v[110:111], v[212:213], v[114:115] op_sel:[1,1,0] op_sel_hi:[1,0,1] neg_lo:[1,0,0]
    v_pk_mul_f32 v[116:117], v[110:111], v[214:215] op_sel:[0,0] op_sel_hi:[0,1]
    v_pk_fma_f32 v[116:117], v[110:111], v[214:215], v[116:117] op_sel:[1,1,0] op_sel_hi:[1,0,1] neg_lo:[1,0,0]
    v_pk_mul_f32 v[118:119], v[114:115], v[210:211] op_sel:[0,0] op_sel_hi:[0,1]
    v_pk_fma_f32 v[118:119], v[114:115], v[210:211], v[118:119] op_sel:[1,1,0] op_sel_hi:[1,0,1] neg_lo:[1,0,0]
    ds_write_b128 v52, v[164:167] offset:0
    v_cvt_pk_bf16_f32 v168, v110, v112
    v_cvt_pk_bf16_f32 v169, v114, v114
    v_cvt_pk_bf16_f32 v170, v114, v118
    v_cvt_pk_bf16_f32 v171, v116, v116
    v_cvt_pk_bf16_f32 v172, -v111, -v113
    v_cvt_pk_bf16_f32 v173, -v115, -v115
    v_cvt_pk_bf16_f32 v174, -v115, -v119
    v_cvt_pk_bf16_f32 v175, -v117, -v117
    v_pk_mul_f32 v[120:121], v[110:111], v[216:217] op_sel:[0,0] op_sel_hi:[0,1]
    v_pk_fma_f32 v[120:121], v[110:111], v[216:217], v[120:121] op_sel:[1,1,0] op_sel_hi:[1,0,1] neg_lo:[1,0,0]
    v_pk_mul_f32 v[122:123], v[120:121], v[212:213] op_sel:[0,0] op_sel_hi:[0,1]
    v_pk_fma_f32 v[122:123], v[120:121], v[212:213], v[122:123] op_sel:[1,1,0] op_sel_hi:[1,0,1] neg_lo:[1,0,0]
    v_pk_mul_f32 v[124:125], v[120:121], v[214:215] op_sel:[0,0] op_sel_hi:[0,1]
    ds_write_b128 v49, v[168:171] offset:0
    v_pk_fma_f32 v[124:125], v[120:121], v[214:215], v[124:125] op_sel:[1,1,0] op_sel_hi:[1,0,1] neg_lo:[1,0,0]
    v_pk_mul_f32 v[126:127], v[120:121], v[216:217] op_sel:[0,0] op_sel_hi:[0,1]
    v_pk_fma_f32 v[126:127], v[120:121], v[216:217], v[126:127] op_sel:[1,1,0] op_sel_hi:[1,0,1] neg_lo:[1,0,0]
    v_pk_mul_f32 v[128:129], v[126:127], v[212:213] op_sel:[0,0] op_sel_hi:[0,1]
    v_pk_fma_f32 v[128:129], v[126:127], v[212:213], v[128:129] op_sel:[1,1,0] op_sel_hi:[1,0,1] neg_lo:[1,0,0]
    v_pk_mul_f32 v[130:131], v[126:127], v[214:215] op_sel:[0,0] op_sel_hi:[0,1]
    v_pk_fma_f32 v[130:131], v[126:127], v[214:215], v[130:131] op_sel:[1,1,0] op_sel_hi:[1,0,1] neg_lo:[1,0,0]
    v_cvt_pk_bf16_f32 v160, v120, v122
    v_cvt_pk_bf16_f32 v161, v126, v128
    v_cvt_pk_bf16_f32 v162, v122, v124
    v_cvt_pk_bf16_f32 v163, v128, v130
    v_cvt_pk_bf16_f32 v164, -v121, -v123
    v_cvt_pk_bf16_f32 v165, -v127, -v129
    ds_write_b128 v53, v[172:175] offset:0
    v_cvt_pk_bf16_f32 v166, -v123, -v125
    v_cvt_pk_bf16_f32 v167, -v129, -v131
    v_pk_mul_f32 v[132:133], v[126:127], v[216:217] op_sel:[0,0] op_sel_hi:[0,1]
    v_pk_fma_f32 v[132:133], v[126:127], v[216:217], v[132:133] op_sel:[1,1,0] op_sel_hi:[1,0,1] neg_lo:[1,0,0]
    v_pk_mul_f32 v[134:135], v[132:133], v[214:215] op_sel:[0,0] op_sel_hi:[0,1]
    v_pk_fma_f32 v[134:135], v[132:133], v[214:215], v[134:135] op_sel:[1,1,0] op_sel_hi:[1,0,1] neg_lo:[1,0,0]
    v_pk_mul_f32 v[136:137], v[132:133], v[216:217] op_sel:[0,0] op_sel_hi:[0,1]
    v_pk_fma_f32 v[136:137], v[132:133], v[216:217], v[136:137] op_sel:[1,1,0] op_sel_hi:[1,0,1] neg_lo:[1,0,0]
    v_pk_mul_f32 v[138:139], v[136:137], v[214:215] op_sel:[0,0] op_sel_hi:[0,1]
    v_pk_fma_f32 v[138:139], v[136:137], v[214:215], v[138:139] op_sel:[1,1,0] op_sel_hi:[1,0,1] neg_lo:[1,0,0]
    v_pk_mul_f32 v[140:141], v[136:137], v[216:217] op_sel:[0,0] op_sel_hi:[0,1]
    v_pk_fma_f32 v[140:141], v[136:137], v[216:217], v[140:141] op_sel:[1,1,0] op_sel_hi:[1,0,1] neg_lo:[1,0,0]
    v_pk_mul_f32 v[142:143], v[140:141], v[214:215] op_sel:[0,0] op_sel_hi:[0,1]
    ds_write_b128 v50, v[160:163] offset:0
    v_pk_fma_f32 v[142:143], v[140:141], v[214:215], v[142:143] op_sel:[1,1,0] op_sel_hi:[1,0,1] neg_lo:[1,0,0]
    v_pk_mul_f32 v[144:145], v[140:141], v[216:217] op_sel:[0,0] op_sel_hi:[0,1]
    v_pk_fma_f32 v[144:145], v[140:141], v[216:217], v[144:145] op_sel:[1,1,0] op_sel_hi:[1,0,1] neg_lo:[1,0,0]
    v_pk_mul_f32 v[146:147], v[144:145], v[214:215] op_sel:[0,0] op_sel_hi:[0,1]
    v_pk_fma_f32 v[146:147], v[144:145], v[214:215], v[146:147] op_sel:[1,1,0] op_sel_hi:[1,0,1] neg_lo:[1,0,0]
    v_cvt_pk_bf16_f32 v168, v132, v136
    v_cvt_pk_bf16_f32 v169, v140, v144
    v_cvt_pk_bf16_f32 v170, v134, v138
    v_cvt_pk_bf16_f32 v171, v142, v146
    v_cvt_pk_bf16_f32 v172, -v133, -v137
    v_cvt_pk_bf16_f32 v173, -v141, -v145
    v_cvt_pk_bf16_f32 v174, -v135, -v139
    v_cvt_pk_bf16_f32 v175, -v143, -v147
    ds_write_b128 v54, v[164:167] offset:0
    v_mov_b32 v96, 1.0
    v_mov_b32 v97, 0
    v_mov_b32 v98, v214
    v_mov_b32 v99, v215
    v_pk_mul_f32 v[220:221], v[214:215], v[214:215] op_sel:[0,0] op_sel_hi:[0,1]
    v_pk_fma_f32 v[220:221], v[214:215], v[214:215], v[220:221] op_sel:[1,1,0] op_sel_hi:[1,0,1] neg_lo:[1,0,0]
    v_mov_b32 v100, v220
    v_mov_b32 v101, v221
    v_pk_mul_f32 v[102:103], v[98:99], v[220:221] op_sel:[0,0] op_sel_hi:[0,1]
    v_pk_fma_f32 v[102:103], v[98:99], v[220:221], v[102:103] op_sel:[1,1,0] op_sel_hi:[1,0,1] neg_lo:[1,0,0]
    v_pk_mul_f32 v[104:105], v[100:101], v[220:221] op_sel:[0,0] op_sel_hi:[0,1]
    v_pk_fma_f32 v[104:105], v[100:101], v[220:221], v[104:105] op_sel:[1,1,0] op_sel_hi:[1,0,1] neg_lo:[1,0,0]
    v_pk_mul_f32 v[106:107], v[102:103], v[220:221] op_sel:[0,0] op_sel_hi:[0,1]
    ds_write_b128 v51, v[168:171] offset:0
    v_pk_fma_f32 v[106:107], v[102:103], v[220:221], v[106:107] op_sel:[1,1,0] op_sel_hi:[1,0,1] neg_lo:[1,0,0]
    v_pk_mul_f32 v[108:109], v[104:105], v[220:221] op_sel:[0,0] op_sel_hi:[0,1]
    v_pk_fma_f32 v[108:109], v[104:105], v[220:221], v[108:109] op_sel:[1,1,0] op_sel_hi:[1,0,1] neg_lo:[1,0,0]
    v_pk_mul_f32 v[110:111], v[106:107], v[220:221] op_sel:[0,0] op_sel_hi:[0,1]
    v_pk_fma_f32 v[110:111], v[106:107], v[220:221], v[110:111] op_sel:[1,1,0] op_sel_hi:[1,0,1] neg_lo:[1,0,0]
    v_cvt_pk_bf16_f32 v160, v96, v98
    v_cvt_pk_bf16_f32 v161, v100, v102
    v_cvt_pk_bf16_f32 v162, v104, v106
    v_cvt_pk_bf16_f32 v163, v108, v110
    v_cvt_pk_bf16_f32 v164, v97, v99
    v_cvt_pk_bf16_f32 v165, v101, v103
    v_cvt_pk_bf16_f32 v166, v105, v107
    v_cvt_pk_bf16_f32 v167, v109, v111
    ds_write_b128 v55, v[172:175] offset:0
    v_pk_mul_f32 v[112:113], v[108:109], v[220:221] op_sel:[0,0] op_sel_hi:[0,1]
    v_pk_fma_f32 v[112:113], v[108:109], v[220:221], v[112:113] op_sel:[1,1,0] op_sel_hi:[1,0,1] neg_lo:[1,0,0]
    v_pk_mul_f32 v[114:115], v[110:111], v[220:221] op_sel:[0,0] op_sel_hi:[0,1]
    v_pk_fma_f32 v[114:115], v[110:111], v[220:221], v[114:115] op_sel:[1,1,0] op_sel_hi:[1,0,1] neg_lo:[1,0,0]
    v_pk_mul_f32 v[116:117], v[112:113], v[220:221] op_sel:[0,0] op_sel_hi:[0,1]
    v_pk_fma_f32 v[116:117], v[112:113], v[220:221], v[116:117] op_sel:[1,1,0] op_sel_hi:[1,0,1] neg_lo:[1,0,0]
    v_pk_mul_f32 v[118:119], v[114:115], v[220:221] op_sel:[0,0] op_sel_hi:[0,1]
    v_pk_fma_f32 v[118:119], v[114:115], v[220:221], v[118:119] op_sel:[1,1,0] op_sel_hi:[1,0,1] neg_lo:[1,0,0]
    v_pk_mul_f32 v[120:121], v[116:117], v[220:221] op_sel:[0,0] op_sel_hi:[0,1]
    v_pk_fma_f32 v[120:121], v[116:117], v[220:221], v[120:121] op_sel:[1,1,0] op_sel_hi:[1,0,1] neg_lo:[1,0,0]
    v_pk_mul_f32 v[122:123], v[118:119], v[220:221] op_sel:[0,0] op_sel_hi:[0,1]
    v_pk_fma_f32 v[122:123], v[118:119], v[220:221], v[122:123] op_sel:[1,1,0] op_sel_hi:[1,0,1] neg_lo:[1,0,0]
    v_pk_mul_f32 v[124:125], v[120:121], v[220:221] op_sel:[0,0] op_sel_hi:[0,1]
    ds_write_b128 v48, v[160:163] offset:8192
    v_pk_fma_f32 v[124:125], v[120:121], v[220:221], v[124:125] op_sel:[1,1,0] op_sel_hi:[1,0,1] neg_lo:[1,0,0]
    v_pk_mul_f32 v[126:127], v[122:123], v[220:221] op_sel:[0,0] op_sel_hi:[0,1]
    v_pk_fma_f32 v[126:127], v[122:123], v[220:221], v[126:127] op_sel:[1,1,0] op_sel_hi:[1,0,1] neg_lo:[1,0,0]
    v_cvt_pk_bf16_f32 v168, v112, v114
    v_cvt_pk_bf16_f32 v169, v116, v118
    v_cvt_pk_bf16_f32 v170, v120, v122
    v_cvt_pk_bf16_f32 v171, v124, v126
    v_cvt_pk_bf16_f32 v172, v113, v115
    v_cvt_pk_bf16_f32 v173, v117, v119
    v_cvt_pk_bf16_f32 v174, v121, v123
    v_cvt_pk_bf16_f32 v175, v125, v127
    v_pk_mul_f32 v[128:129], v[124:125], v[220:221] op_sel:[0,0] op_sel_hi:[0,1]
    v_pk_fma_f32 v[128:129], v[124:125], v[220:221], v[128:129] op_sel:[1,1,0] op_sel_hi:[1,0,1] neg_lo:[1,0,0]
    ds_write_b128 v52, v[164:167] offset:8192
    v_pk_mul_f32 v[130:131], v[126:127], v[220:221] op_sel:[0,0] op_sel_hi:[0,1]
    v_pk_fma_f32 v[130:131], v[126:127], v[220:221], v[130:131] op_sel:[1,1,0] op_sel_hi:[1,0,1] neg_lo:[1,0,0]
    v_pk_mul_f32 v[132:133], v[128:129], v[220:221] op_sel:[0,0] op_sel_hi:[0,1]
    v_pk_fma_f32 v[132:133], v[128:129], v[220:221], v[132:133] op_sel:[1,1,0] op_sel_hi:[1,0,1] neg_lo:[1,0,0]
    v_pk_mul_f32 v[134:135], v[130:131], v[220:221] op_sel:[0,0] op_sel_hi:[0,1]
    v_pk_fma_f32 v[134:135], v[130:131], v[220:221], v[134:135] op_sel:[1,1,0] op_sel_hi:[1,0,1] neg_lo:[1,0,0]
    v_pk_mul_f32 v[136:137], v[132:133], v[220:221] op_sel:[0,0] op_sel_hi:[0,1]
    v_pk_fma_f32 v[136:137], v[132:133], v[220:221], v[136:137] op_sel:[1,1,0] op_sel_hi:[1,0,1] neg_lo:[1,0,0]
    v_pk_mul_f32 v[138:139], v[134:135], v[220:221] op_sel:[0,0] op_sel_hi:[0,1]
    v_pk_fma_f32 v[138:139], v[134:135], v[220:221], v[138:139] op_sel:[1,1,0] op_sel_hi:[1,0,1] neg_lo:[1,0,0]
    v_pk_mul_f32 v[140:141], v[136:137], v[220:221] op_sel:[0,0] op_sel_hi:[0,1]
    v_pk_fma_f32 v[140:141], v[136:137], v[220:221], v[140:141] op_sel:[1,1,0] op_sel_hi:[1,0,1] neg_lo:[1,0,0]
    v_pk_mul_f32 v[142:143], v[138:139], v[220:221] op_sel:[0,0] op_sel_hi:[0,1]
    ds_write_b128 v49, v[168:171] offset:8192
    v_pk_fma_f32 v[142:143], v[138:139], v[220:221], v[142:143] op_sel:[1,1,0] op_sel_hi:[1,0,1] neg_lo:[1,0,0]
    v_cvt_pk_bf16_f32 v160, v128, v130
    v_cvt_pk_bf16_f32 v161, v132, v134
    v_cvt_pk_bf16_f32 v162, v136, v138
    v_cvt_pk_bf16_f32 v163, v140, v142
    v_cvt_pk_bf16_f32 v164, v129, v131
    v_cvt_pk_bf16_f32 v165, v133, v135
    v_cvt_pk_bf16_f32 v166, v137, v139
    v_cvt_pk_bf16_f32 v167, v141, v143
    v_pk_mul_f32 v[144:145], v[140:141], v[220:221] op_sel:[0,0] op_sel_hi:[0,1]
    v_pk_fma_f32 v[144:145], v[140:141], v[220:221], v[144:145] op_sel:[1,1,0] op_sel_hi:[1,0,1] neg_lo:[1,0,0]
    v_pk_mul_f32 v[146:147], v[142:143], v[220:221] op_sel:[0,0] op_sel_hi:[0,1]
    v_pk_fma_f32 v[146:147], v[142:143], v[220:221], v[146:147] op_sel:[1,1,0] op_sel_hi:[1,0,1] neg_lo:[1,0,0]
    ds_write_b128 v53, v[172:175] offset:8192
    v_pk_mul_f32 v[148:149], v[144:145], v[220:221] op_sel:[0,0] op_sel_hi:[0,1]
    v_pk_fma_f32 v[148:149], v[144:145], v[220:221], v[148:149] op_sel:[1,1,0] op_sel_hi:[1,0,1] neg_lo:[1,0,0]
    v_pk_mul_f32 v[150:151], v[146:147], v[220:221] op_sel:[0,0] op_sel_hi:[0,1]
    v_pk_fma_f32 v[150:151], v[146:147], v[220:221], v[150:151] op_sel:[1,1,0] op_sel_hi:[1,0,1] neg_lo:[1,0,0]
    v_pk_mul_f32 v[152:153], v[148:149], v[220:221] op_sel:[0,0] op_sel_hi:[0,1]
    v_pk_fma_f32 v[152:153], v[148:149], v[220:221], v[152:153] op_sel:[1,1,0] op_sel_hi:[1,0,1] neg_lo:[1,0,0]
    v_pk_mul_f32 v[154:155], v[150:151], v[220:221] op_sel:[0,0] op_sel_hi:[0,1]
    v_pk_fma_f32 v[154:155], v[150:151], v[220:221], v[154:155] op_sel:[1,1,0] op_sel_hi:[1,0,1] neg_lo:[1,0,0]
    v_pk_mul_f32 v[156:157], v[152:153], v[220:221] op_sel:[0,0] op_sel_hi:[0,1]
    v_pk_fma_f32 v[156:157], v[152:153], v[220:221], v[156:157] op_sel:[1,1,0] op_sel_hi:[1,0,1] neg_lo:[1,0,0]
    v_pk_mul_f32 v[158:159], v[154:155], v[220:221] op_sel:[0,0] op_sel_hi:[0,1]
    v_pk_fma_f32 v[158:159], v[154:155], v[220:221], v[158:159] op_sel:[1,1,0] op_sel_hi:[1,0,1] neg_lo:[1,0,0]
    v_cvt_pk_bf16_f32 v168, v144, v146
    ds_write_b128 v50, v[160:163] offset:8192
    v_cvt_pk_bf16_f32 v169, v148, v150
    v_cvt_pk_bf16_f32 v170, v152, v154
    v_cvt_pk_bf16_f32 v171, v156, v158
    v_cvt_pk_bf16_f32 v172, v145, v147
    v_cvt_pk_bf16_f32 v173, v149, v151
    v_cvt_pk_bf16_f32 v174, v153, v155
    v_cvt_pk_bf16_f32 v175, v157, v159
    ds_write_b128 v54, v[164:167] offset:8192
    ds_write_b128 v51, v[168:171] offset:8192
    ds_write_b128 v55, v[172:175] offset:8192
    s_waitcnt vmcnt(0)
    s_waitcnt lgkmcnt(0)
    s_barrier
    s_cmp_lg_u32 s3, 0
    s_cbranch_scc1 sequential_preLN__ssm_conv_s4d__glu_gated_swiglu__prompt_kernel_gst5
    v_add_u32 v4, 147456, v2
    s_mov_b32 exec_lo, 15
    s_mov_b32 exec_hi, 0
    ds_read_b128 v[60:63], v4
    s_lshl_b32 s53, s2, 7
    s_add_u32 s53, s53, 17809408
    s_waitcnt lgkmcnt(0)
    buffer_store_dwordx4 v[60:63], v2, s[32:35], s53 offen sc1
    s_mov_b64 exec, -1
sequential_preLN__ssm_conv_s4d__glu_gated_swiglu__prompt_kernel_gst5:
    s_mov_b32 s40, s20
    s_mov_b32 s41, s21
    s_mov_b32 s42, 1605632
    s_mov_b32 s43, 0x20000
    s_mov_b32 s44, s22
    s_mov_b32 s45, s23
    s_mov_b32 s46, 1605632
    s_mov_b32 s47, 0x20000
    s_mov_b32 s48, s24
    s_mov_b32 s49, s25
    s_mov_b32 s50, 1605632
    s_mov_b32 s51, 0x20000
    v_lshrrev_b32 v4, 3, v1
    v_and_b32 v5, 7, v1
    v_lshlrev_b32 v6, 4, v5
    s_movk_i32 s58, 3584
    v_mad_u32_u24 v250, v4, s58, v6
    s_movk_i32 s58, 896
    v_mad_u32_u24 v251, v4, s58, v6
    v_lshrrev_b32 v252, 2, v5
    v_mul_u32_u24 v252, 1088, v252
    v_lshl_add_u32 v252, v4, 6, v252
    v_and_b32_e64 v6, 3, v5
    v_lshl_add_u32 v252, v6, 4, v252
    s_mul_i32 s58, s3, 4352
    s_add_u32 s58, s58, 106496
    v_add_u32 v252, s58, v252
    v_and_b32 v4, 15, v1
    v_lshrrev_b32_e64 v4, 2, v4
    v_bfe_u32 v6, v1, 4, 1
    v_lshlrev_b32 v6, 5, v6
    v_and_b32 v5, 3, v1
    v_lshl_add_u32 v6, v5, 3, v6
    v_lshl_add_u32 v6, v4, 6, v6
    v_add_u32_e64 v6, s58, v6
    v_lshl_add_u32 v253, v3, 9, v6
    v_lshl_add_u32 v254, v3, 8, v6
    s_lshl_b32 s76, s2, 2
    s_add_u32 s76, s76, s3
    s_and_b32 s62, s76, 1
    s_cmp_eq_u32 s62, 0
    s_cselect_b32 s40, s40, s44
    s_cselect_b32 s41, s41, s45
    s_lshr_b32 s62, s76, 1
    s_mul_i32 s63, s62, 2341
    s_lshr_b32 s63, s63, 16
    s_mul_i32 s64, s63, 28
    s_sub_u32 s64, s62, s64
    s_mul_i32 s65, s63, 57344
    s_lshl_b32 s62, s64, 7
    s_add_u32 s65, s65, s62
    s_mul_i32 s72, s64, 56
    s_add_u32 s72, s72, s63
    s_lshl_b32 s72, s72, 1
    s_and_b32 s62, s76, 1
    s_add_u32 s72, s72, s62
    s_lshl_b32 s72, s72, 10
    s_add_u32 s72, s72, 5505024
    buffer_load_dwordx4 v[16:19], v250, s[40:43], s65 offen
    s_add_u32 s62, s65, 28672
    buffer_load_dwordx4 v[20:23], v250, s[40:43], s62 offen
    s_cmp_ge_u32 s76, 672
    s_cbranch_scc1 sequential_preLN__ssm_conv_s4d__glu_gated_swiglu__prompt_kernel_ub6
    s_lshr_b32 s62, s76, 1
    s_mul_i32 s63, s62, 2341
    s_lshr_b32 s63, s63, 16
    s_mul_i32 s64, s63, 28
    s_sub_u32 s64, s62, s64
    s_add_u32 s63, s63, 16
    s_mul_i32 s65, s63, 57344
    s_lshl_b32 s62, s64, 7
    s_add_u32 s65, s65, s62
    s_mul_i32 s73, s64, 56
    s_add_u32 s73, s73, s63
    s_lshl_b32 s73, s73, 1
    s_and_b32 s62, s76, 1
    s_add_u32 s73, s73, s62
    s_lshl_b32 s73, s73, 10
    s_add_u32 s73, s73, 5505024
    buffer_load_dwordx4 v[24:27], v250, s[40:43], s65 offen
    s_add_u32 s62, s65, 28672
    buffer_load_dwordx4 v[28:31], v250, s[40:43], s62 offen
    s_branch sequential_preLN__ssm_conv_s4d__glu_gated_swiglu__prompt_kernel_ube7
sequential_preLN__ssm_conv_s4d__glu_gated_swiglu__prompt_kernel_ub6:
    s_sub_u32 s79, s76, 672
    s_mul_i32 s62, s79, 9363
    s_lshr_b32 s62, s62, 16
    s_mul_i32 s63, s62, 7
    s_sub_u32 s63, s79, s63
    s_mul_i32 s65, s62, 14336
    s_lshl_b32 s64, s63, 7
    s_add_u32 s65, s65, s64
    s_mul_i32 s73, s63, 112
    s_add_u32 s73, s73, s62
    s_lshl_b32 s73, s73, 11
    s_add_u32 s73, s73, 8716288
    buffer_load_dwordx4 v[24:27], v251, s[48:51], s65 offen
    s_add_u32 s62, s65, 7168
    buffer_load_dwordx4 v[28:31], v251, s[48:51], s62 offen
sequential_preLN__ssm_conv_s4d__glu_gated_swiglu__prompt_kernel_ube7:
    s_cmp_ge_u32 s76, 672
    s_cselect_b64 vcc, -1, 0
    v_cndmask_b32 v254, v253, v254, vcc
    s_movk_i32 s53, 512
    s_cselect_b32 s53, s53, 256
    v_add_u32 v251, s53, v254
    s_movk_i32 s53, 1024
    s_cselect_b32 s53, s53, 57344
    s_add_u32 s75, s73, s53
    s_add_u32 s74, s72, 57344
    v_and_b32 v224, 0xffff0000, v248
    v_mul_f32 v224, 0x3fb8aa3b, v224
    ds_read_b64_tr_b16 a[0:1], v56 offset:0
    v_lshlrev_b32_e64 v225, 16, v244
    ds_read_b64_tr_b16 a[4:5], v56 offset:8192
    v_lshlrev_b32_e64 v226, 16, v245
    ds_read_b64_tr_b16 a[2:3], v57 offset:0
    v_lshlrev_b32_e64 v227, 16, v246
    ds_read_b64_tr_b16 a[6:7], v57 offset:8192
    v_lshlrev_b32 v228, 16, v247
    v_exp_f32 v224, v224
    ds_read_b64_tr_b16 a[8:9], v56 offset:1024
    v_mul_f32 v225, 0x3fb8aa3b, v225
    ds_read_b64_tr_b16 a[12:13], v56 offset:9216
    v_exp_f32_e64 v225, v225
    ds_read_b64_tr_b16 a[10:11], v57 offset:1024
    v_cvt_pk_bf16_f32 v224, v224, v224
    ds_read_b64_tr_b16 a[14:15], v57 offset:9216
    v_and_b32 v224, 0xffff0000, v224
    v_cvt_pk_bf16_f32 v225, v225, v225
    ds_read_b64_tr_b16 a[16:17], v56 offset:2048
    v_and_b32 v225, 0xffff0000, v225
    ds_read_b64_tr_b16 a[20:21], v56 offset:10240
    v_mul_f32_e64 v226, v226, v224
    ds_read_b64_tr_b16 a[18:19], v57 offset:2048
    v_mul_f32_e64 v225, v225, v224
    ds_read_b64_tr_b16 a[22:23], v57 offset:10240
    v_mul_f32 v218, v227, v224
    v_mul_f32 v219, v228, v224
    ds_read_b64_tr_b16 a[24:25], v56 offset:3072
    v_mul_f32 v225, 0xbfb8aa3b, v225
    ds_read_b64_tr_b16 a[28:29], v56 offset:11264
    v_mul_f32 v226, 0x3e22f983, v226
    ds_read_b64_tr_b16 a[26:27], v57 offset:3072
    v_pk_add_f32 v[218:219], v[218:219], v[218:219]
    ds_read_b64_tr_b16 a[30:31], v57 offset:11264
    v_mul_f32 v233, 0x43800000, v225
    v_mul_f32 v234, 0x43800000, v226
    ds_read_b64_tr_b16 a[32:33], v56 offset:4096
    v_exp_f32 v229, v225
    ds_read_b64_tr_b16 a[36:37], v56 offset:12288
    v_fract_f32_e64 v230, v226
    ds_read_b64_tr_b16 a[34:35], v57 offset:4096
    v_exp_f32_e64 v233, v233
    ds_read_b64_tr_b16 a[38:39], v57 offset:12288
    v_fract_f32 v234, v234
    v_cos_f32 v231, v230
    ds_read_b64_tr_b16 a[40:41], v56 offset:5120
    v_sin_f32_e64 v232, v230
    ds_read_b64_tr_b16 a[44:45], v56 offset:13312
    v_cos_f32_e64 v235, v234
    ds_read_b64_tr_b16 a[42:43], v57 offset:5120
    v_sin_f32_e64 v236, v234
    ds_read_b64_tr_b16 a[46:47], v57 offset:13312
    v_mul_f32 v208, v229, v231
    v_mul_f32 v209, v229, v232
    ds_read_b64_tr_b16 a[48:49], v56 offset:6144
    v_mul_f32_e64 v216, v233, v235
    ds_read_b64_tr_b16 a[52:53], v56 offset:14336
    v_mul_f32_e64 v217, v233, v236
    ds_read_b64_tr_b16 a[50:51], v57 offset:6144
    v_pk_mul_f32 v[210:211], v[208:209], v[208:209] op_sel:[0,0] op_sel_hi:[0,1]
    ds_read_b64_tr_b16 a[54:55], v57 offset:14336
    v_pk_fma_f32 v[210:211], v[208:209], v[208:209], v[210:211] op_sel:[1,1,0] op_sel_hi:[1,0,1] neg_lo:[1,0,0]
    v_pk_mul_f32 v[212:213], v[210:211], v[210:211] op_sel:[0,0] op_sel_hi:[0,1]
    ds_read_b64_tr_b16 a[56:57], v56 offset:7168
    v_pk_fma_f32 v[212:213], v[210:211], v[210:211], v[212:213] op_sel:[1,1,0] op_sel_hi:[1,0,1] neg_lo:[1,0,0]
    ds_read_b64_tr_b16 a[60:61], v56 offset:15360
    v_pk_mul_f32 v[214:215], v[212:213], v[212:213] op_sel:[0,0] op_sel_hi:[0,1]
    ds_read_b64_tr_b16 a[58:59], v57 offset:7168
    v_pk_fma_f32 v[214:215], v[212:213], v[212:213], v[214:215] op_sel:[1,1,0] op_sel_hi:[1,0,1] neg_lo:[1,0,0]
    ds_read_b64_tr_b16 a[62:63], v57 offset:15360
    v_pk_mul_f32 v[96:97], v[218:219], v[208:209] op_sel:[0,0] op_sel_hi:[0,1]
    v_pk_fma_f32 v[96:97], v[218:219], v[208:209], v[96:97] op_sel:[1,1,0] op_sel_hi:[1,0,1] neg_lo:[1,0,0]
    v_pk_mul_f32 v[98:99], v[96:97], v[208:209] op_sel:[0,0] op_sel_hi:[0,1]
    v_pk_fma_f32 v[98:99], v[96:97], v[208:209], v[98:99] op_sel:[1,1,0] op_sel_hi:[1,0,1] neg_lo:[1,0,0]
    v_pk_mul_f32 v[100:101], v[98:99], v[208:209] op_sel:[0,0] op_sel_hi:[0,1]
    v_pk_fma_f32 v[100:101], v[98:99], v[208:209], v[100:101] op_sel:[1,1,0] op_sel_hi:[1,0,1] neg_lo:[1,0,0]
    v_pk_mul_f32 v[102:103], v[100:101], v[208:209] op_sel:[0,0] op_sel_hi:[0,1]
    v_pk_fma_f32 v[102:103], v[100:101], v[208:209], v[102:103] op_sel:[1,1,0] op_sel_hi:[1,0,1] neg_lo:[1,0,0]
    v_pk_mul_f32 v[104:105], v[102:103], v[208:209] op_sel:[0,0] op_sel_hi:[0,1]
    v_pk_fma_f32 v[104:105], v[102:103], v[208:209], v[104:105] op_sel:[1,1,0] op_sel_hi:[1,0,1] neg_lo:[1,0,0]
    v_pk_mul_f32 v[106:107], v[104:105], v[208:209] op_sel:[0,0] op_sel_hi:[0,1]
    v_pk_fma_f32 v[106:107], v[104:105], v[208:209], v[106:107] op_sel:[1,1,0] op_sel_hi:[1,0,1] neg_lo:[1,0,0]
    v_pk_mul_f32 v[108:109], v[106:107], v[208:209] op_sel:[0,0] op_sel_hi:[0,1]
    v_pk_fma_f32 v[108:109], v[106:107], v[208:209], v[108:109] op_sel:[1,1,0] op_sel_hi:[1,0,1] neg_lo:[1,0,0]
    v_cvt_pk_bf16_f32 v160, v218, v96
    v_mfma_f32_32x32x16_bf16 v[64:79], a[0:3], a[4:7], 0
    v_cvt_pk_bf16_f32 v161, v98, v100
    v_cvt_pk_bf16_f32 v162, v102, v104
    v_cvt_pk_bf16_f32 v163, v106, v108
    v_cvt_pk_bf16_f32 v164, -v219, -v97
    ds_write_b128 v48, v[160:163] offset:16384
    v_cvt_pk_bf16_f32 v165, -v99, -v101
    v_cvt_pk_bf16_f32 v166, -v103, -v105
    v_cvt_pk_bf16_f32 v167, -v107, -v109
    v_pk_mul_f32 v[110:111], v[218:219], v[216:217] op_sel:[0,0] op_sel_hi:[0,1]
    v_pk_fma_f32 v[110:111], v[218:219], v[216:217], v[110:111] op_sel:[1,1,0] op_sel_hi:[1,0,1] neg_lo:[1,0,0]
    v_mfma_f32_32x32x16_bf16 v[64:79], a[8:11], a[12:15], v[64:79]
    v_pk_mul_f32 v[112:113], v[110:111], v[210:211] op_sel:[0,0] op_sel_hi:[0,1]
    v_pk_fma_f32 v[112:113], v[110:111], v[210:211], v[112:113] op_sel:[1,1,0] op_sel_hi:[1,0,1] neg_lo:[1,0,0]
    v_pk_mul_f32 v[114:115], v[110:111], v[212:213] op_sel:[0,0] op_sel_hi:[0,1]
    v_pk_fma_f32 v[114:115], v[110:111], v[212:213], v[114:115] op_sel:[1,1,0] op_sel_hi:[1,0,1] neg_lo:[1,0,0]
    v_pk_mul_f32 v[116:117], v[110:111], v[214:215] op_sel:[0,0] op_sel_hi:[0,1]
    v_pk_fma_f32 v[116:117], v[110:111], v[214:215], v[116:117] op_sel:[1,1,0] op_sel_hi:[1,0,1] neg_lo:[1,0,0]
    v_pk_mul_f32 v[118:119], v[114:115], v[210:211] op_sel:[0,0] op_sel_hi:[0,1]
    v_pk_fma_f32 v[118:119], v[114:115], v[210:211], v[118:119] op_sel:[1,1,0] op_sel_hi:[1,0,1] neg_lo:[1,0,0]
    ds_write_b128 v52, v[164:167] offset:16384
    v_cvt_pk_bf16_f32 v168, v110, v112
    v_mfma_f32_32x32x16_bf16 v[64:79], a[16:19], a[20:23], v[64:79]
    v_cvt_pk_bf16_f32 v169, v114, v114
    v_cvt_pk_bf16_f32 v170, v114, v118
    v_cvt_pk_bf16_f32 v171, v116, v116
    v_cvt_pk_bf16_f32 v172, -v111, -v113
    v_cvt_pk_bf16_f32 v173, -v115, -v115
    v_cvt_pk_bf16_f32 v174, -v115, -v119
    v_cvt_pk_bf16_f32 v175, -v117, -v117
    v_pk_mul_f32 v[120:121], v[110:111], v[216:217] op_sel:[0,0] op_sel_hi:[0,1]
    v_pk_fma_f32 v[120:121], v[110:111], v[216:217], v[120:121] op_sel:[1,1,0] op_sel_hi:[1,0,1] neg_lo:[1,0,0]
    v_pk_mul_f32 v[122:123], v[120:121], v[212:213] op_sel:[0,0] op_sel_hi:[0,1]
    v_mfma_f32_32x32x16_bf16 v[64:79], a[24:27], a[28:31], v[64:79]
    v_pk_fma_f32 v[122:123], v[120:121], v[212:213], v[122:123] op_sel:[1,1,0] op_sel_hi:[1,0,1] neg_lo:[1,0,0]
    v_pk_mul_f32 v[124:125], v[120:121], v[214:215] op_sel:[0,0] op_sel_hi:[0,1]
    ds_write_b128 v49, v[168:171] offset:16384
    v_pk_fma_f32 v[124:125], v[120:121], v[214:215], v[124:125] op_sel:[1,1,0] op_sel_hi:[1,0,1] neg_lo:[1,0,0]
    v_pk_mul_f32 v[126:127], v[120:121], v[216:217] op_sel:[0,0] op_sel_hi:[0,1]
    v_pk_fma_f32 v[126:127], v[120:121], v[216:217], v[126:127] op_sel:[1,1,0] op_sel_hi:[1,0,1] neg_lo:[1,0,0]
    v_pk_mul_f32 v[128:129], v[126:127], v[212:213] op_sel:[0,0] op_sel_hi:[0,1]
    v_pk_fma_f32 v[128:129], v[126:127], v[212:213], v[128:129] op_sel:[1,1,0] op_sel_hi:[1,0,1] neg_lo:[1,0,0]
    v_pk_mul_f32 v[130:131], v[126:127], v[214:215] op_sel:[0,0] op_sel_hi:[0,1]
    v_pk_fma_f32 v[130:131], v[126:127], v[214:215], v[130:131] op_sel:[1,1,0] op_sel_hi:[1,0,1] neg_lo:[1,0,0]
    v_cvt_pk_bf16_f32 v160, v120, v122
    v_mfma_f32_32x32x16_bf16 v[64:79], a[32:35], a[36:39], v[64:79]
    v_cvt_pk_bf16_f32 v161, v126, v128
    v_cvt_pk_bf16_f32 v162, v122, v124
    v_cvt_pk_bf16_f32 v163, v128, v130
    v_cvt_pk_bf16_f32 v164, -v121, -v123
    v_cvt_pk_bf16_f32 v165, -v127, -v129
    ds_write_b128 v53, v[172:175] offset:16384
    v_cvt_pk_bf16_f32 v166, -v123, -v125
    v_cvt_pk_bf16_f32 v167, -v129, -v131
    v_pk_mul_f32 v[132:133], v[126:127], v[216:217] op_sel:[0,0] op_sel_hi:[0,1]
    v_pk_fma_f32 v[132:133], v[126:127], v[216:217], v[132:133] op_sel:[1,1,0] op_sel_hi:[1,0,1] neg_lo:[1,0,0]
    s_waitcnt lgkmcnt(12)
    v_mfma_f32_32x32x16_bf16 v[64:79], a[40:43], a[44:47], v[64:79]
    v_pk_mul_f32 v[134:135], v[132:133], v[214:215] op_sel:[0,0] op_sel_hi:[0,1]
    v_pk_fma_f32 v[134:135], v[132:133], v[214:215], v[134:135] op_sel:[1,1,0] op_sel_hi:[1,0,1] neg_lo:[1,0,0]
    v_pk_mul_f32 v[136:137], v[132:133], v[216:217] op_sel:[0,0] op_sel_hi:[0,1]
    v_pk_fma_f32 v[136:137], v[132:133], v[216:217], v[136:137] op_sel:[1,1,0] op_sel_hi:[1,0,1] neg_lo:[1,0,0]
    v_pk_mul_f32 v[138:139], v[136:137], v[214:215] op_sel:[0,0] op_sel_hi:[0,1]
    v_pk_fma_f32 v[138:139], v[136:137], v[214:215], v[138:139] op_sel:[1,1,0] op_sel_hi:[1,0,1] neg_lo:[1,0,0]
    v_pk_mul_f32 v[140:141], v[136:137], v[216:217] op_sel:[0,0] op_sel_hi:[0,1]
    v_pk_fma_f32 v[140:141], v[136:137], v[216:217], v[140:141] op_sel:[1,1,0] op_sel_hi:[1,0,1] neg_lo:[1,0,0]
    v_pk_mul_f32 v[142:143], v[140:141], v[214:215] op_sel:[0,0] op_sel_hi:[0,1]
    ds_write_b128 v50, v[160:163] offset:16384
    s_waitcnt lgkmcnt(9)
    v_mfma_f32_32x32x16_bf16 v[64:79], a[48:51], a[52:55], v[64:79]
    v_pk_fma_f32 v[142:143], v[140:141], v[214:215], v[142:143] op_sel:[1,1,0] op_sel_hi:[1,0,1] neg_lo:[1,0,0]
    v_pk_mul_f32 v[144:145], v[140:141], v[216:217] op_sel:[0,0] op_sel_hi:[0,1]
    v_pk_fma_f32 v[144:145], v[140:141], v[216:217], v[144:145] op_sel:[1,1,0] op_sel_hi:[1,0,1] neg_lo:[1,0,0]
    v_pk_mul_f32 v[146:147], v[144:145], v[214:215] op_sel:[0,0] op_sel_hi:[0,1]
    v_pk_fma_f32 v[146:147], v[144:145], v[214:215], v[146:147] op_sel:[1,1,0] op_sel_hi:[1,0,1] neg_lo:[1,0,0]
    v_cvt_pk_bf16_f32 v168, v132, v136
    v_cvt_pk_bf16_f32 v169, v140, v144
    v_cvt_pk_bf16_f32 v170, v134, v138
    v_cvt_pk_bf16_f32 v171, v142, v146
    v_cvt_pk_bf16_f32 v172, -v133, -v137
    s_waitcnt lgkmcnt(5)
    v_mfma_f32_32x32x16_bf16 v[64:79], a[56:59], a[60:63], v[64:79]
    v_cvt_pk_bf16_f32 v173, -v141, -v145
    v_cvt_pk_bf16_f32 v174, -v135, -v139
    v_cvt_pk_bf16_f32 v175, -v143, -v147
    ds_write_b128 v54, v[164:167] offset:16384
    ds_write_b128 v51, v[168:171] offset:16384
    ds_write_b128 v55, v[172:175] offset:16384
    v_lshlrev_b32 v4, 7, v0
    s_mov_b32 s53, 17809408
    buffer_load_dwordx4 v[32:35], v4, s[32:35], s53 offen offset:0 sc1
    buffer_load_dwordx4 v[36:39], v4, s[32:35], s53 offen offset:16 sc1
    buffer_load_dwordx4 v[40:43], v4, s[32:35], s53 offen offset:32 sc1
    buffer_load_dwordx4 v[44:47], v4, s[32:35], s53 offen offset:48 sc1
    v_mov_b32 v96, 1.0
    v_mov_b32 v97, 0
    v_mov_b32 v98, v214
    v_mov_b32 v99, v215
    v_pk_mul_f32 v[220:221], v[214:215], v[214:215] op_sel:[0,0] op_sel_hi:[0,1]
    v_pk_fma_f32 v[220:221], v[214:215], v[214:215], v[220:221] op_sel:[1,1,0] op_sel_hi:[1,0,1] neg_lo:[1,0,0]
    v_mov_b32 v100, v220
    v_mov_b32 v101, v221
    v_pk_mul_f32 v[102:103], v[98:99], v[220:221] op_sel:[0,0] op_sel_hi:[0,1]
    v_pk_fma_f32 v[102:103], v[98:99], v[220:221], v[102:103] op_sel:[1,1,0] op_sel_hi:[1,0,1] neg_lo:[1,0,0]
    v_pk_mul_f32 v[104:105], v[100:101], v[220:221] op_sel:[0,0] op_sel_hi:[0,1]
    v_pk_fma_f32 v[104:105], v[100:101], v[220:221], v[104:105] op_sel:[1,1,0] op_sel_hi:[1,0,1] neg_lo:[1,0,0]
    v_pk_mul_f32 v[106:107], v[102:103], v[220:221] op_sel:[0,0] op_sel_hi:[0,1]
    v_pk_fma_f32 v[106:107], v[102:103], v[220:221], v[106:107] op_sel:[1,1,0] op_sel_hi:[1,0,1] neg_lo:[1,0,0]
    v_pk_mul_f32 v[108:109], v[104:105], v[220:221] op_sel:[0,0] op_sel_hi:[0,1]
    v_pk_fma_f32 v[108:109], v[104:105], v[220:221], v[108:109] op_sel:[1,1,0] op_sel_hi:[1,0,1] neg_lo:[1,0,0]
    v_pk_mul_f32 v[110:111], v[106:107], v[220:221] op_sel:[0,0] op_sel_hi:[0,1]
    v_pk_fma_f32 v[110:111], v[106:107], v[220:221], v[110:111] op_sel:[1,1,0] op_sel_hi:[1,0,1] neg_lo:[1,0,0]
    v_cvt_pk_bf16_f32 v160, v96, v98
    v_cvt_pk_bf16_f32 v161, v100, v102
    v_cvt_pk_bf16_f32 v162, v104, v106
    v_cvt_pk_bf16_f32 v163, v108, v110
    v_cvt_pk_bf16_f32 v164, v97, v99
    ds_write_b128 v48, v[160:163] offset:8192
    v_cvt_pk_bf16_f32 v165, v101, v103
    v_cvt_pk_bf16_f32 v166, v105, v107
    v_cvt_pk_bf16_f32 v167, v109, v111
    v_pk_mul_f32 v[112:113], v[108:109], v[220:221] op_sel:[0,0] op_sel_hi:[0,1]
    v_pk_fma_f32 v[112:113], v[108:109], v[220:221], v[112:113] op_sel:[1,1,0] op_sel_hi:[1,0,1] neg_lo:[1,0,0]
    v_pk_mul_f32 v[114:115], v[110:111], v[220:221] op_sel:[0,0] op_sel_hi:[0,1]
    v_pk_fma_f32 v[114:115], v[110:111], v[220:221], v[114:115] op_sel:[1,1,0] op_sel_hi:[1,0,1] neg_lo:[1,0,0]
    v_pk_mul_f32 v[116:117], v[112:113], v[220:221] op_sel:[0,0] op_sel_hi:[0,1]
    v_pk_fma_f32 v[116:117], v[112:113], v[220:221], v[116:117] op_sel:[1,1,0] op_sel_hi:[1,0,1] neg_lo:[1,0,0]
    v_pk_mul_f32 v[118:119], v[114:115], v[220:221] op_sel:[0,0] op_sel_hi:[0,1]
    v_pk_fma_f32 v[118:119], v[114:115], v[220:221], v[118:119] op_sel:[1,1,0] op_sel_hi:[1,0,1] neg_lo:[1,0,0]
    v_pk_mul_f32 v[120:121], v[116:117], v[220:221] op_sel:[0,0] op_sel_hi:[0,1]
    v_pk_fma_f32 v[120:121], v[116:117], v[220:221], v[120:121] op_sel:[1,1,0] op_sel_hi:[1,0,1] neg_lo:[1,0,0]
    ds_write_b128 v52, v[164:167] offset:8192
    v_pk_mul_f32 v[122:123], v[118:119], v[220:221] op_sel:[0,0] op_sel_hi:[0,1]
    v_pk_fma_f32 v[122:123], v[118:119], v[220:221], v[122:123] op_sel:[1,1,0] op_sel_hi:[1,0,1] neg_lo:[1,0,0]
    v_pk_mul_f32 v[124:125], v[120:121], v[220:221] op_sel:[0,0] op_sel_hi:[0,1]
    v_pk_fma_f32 v[124:125], v[120:121], v[220:221], v[124:125] op_sel:[1,1,0] op_sel_hi:[1,0,1] neg_lo:[1,0,0]
    v_pk_mul_f32 v[126:127], v[122:123], v[220:221] op_sel:[0,0] op_sel_hi:[0,1]
    v_pk_fma_f32 v[126:127], v[122:123], v[220:221], v[126:127] op_sel:[1,1,0] op_sel_hi:[1,0,1] neg_lo:[1,0,0]
    v_cvt_pk_bf16_f32 v168, v112, v114
    v_cvt_pk_bf16_f32 v169, v116, v118
    v_cvt_pk_bf16_f32 v170, v120, v122
    v_cvt_pk_bf16_f32 v171, v124, v126
    v_cvt_pk_bf16_f32 v172, v113, v115
    v_cvt_pk_bf16_f32 v173, v117, v119
    v_cvt_pk_bf16_f32 v174, v121, v123
    ds_write_b128 v49, v[168:171] offset:8192
    v_cvt_pk_bf16_f32 v175, v125, v127
    v_pk_mul_f32 v[128:129], v[124:125], v[220:221] op_sel:[0,0] op_sel_hi:[0,1]
    v_pk_fma_f32 v[128:129], v[124:125], v[220:221], v[128:129] op_sel:[1,1,0] op_sel_hi:[1,0,1] neg_lo:[1,0,0]
    v_pk_mul_f32 v[130:131], v[126:127], v[220:221] op_sel:[0,0] op_sel_hi:[0,1]
    v_pk_fma_f32 v[130:131], v[126:127], v[220:221], v[130:131] op_sel:[1,1,0] op_sel_hi:[1,0,1] neg_lo:[1,0,0]
    v_pk_mul_f32 v[132:133], v[128:129], v[220:221] op_sel:[0,0] op_sel_hi:[0,1]
    v_pk_fma_f32 v[132:133], v[128:129], v[220:221], v[132:133] op_sel:[1,1,0] op_sel_hi:[1,0,1] neg_lo:[1,0,0]
    v_pk_mul_f32 v[134:135], v[130:131], v[220:221] op_sel:[0,0] op_sel_hi:[0,1]
    v_pk_fma_f32 v[134:135], v[130:131], v[220:221], v[134:135] op_sel:[1,1,0] op_sel_hi:[1,0,1] neg_lo:[1,0,0]
    v_pk_mul_f32 v[136:137], v[132:133], v[220:221] op_sel:[0,0] op_sel_hi:[0,1]
    v_pk_fma_f32 v[136:137], v[132:133], v[220:221], v[136:137] op_sel:[1,1,0] op_sel_hi:[1,0,1] neg_lo:[1,0,0]
    v_pk_mul_f32 v[138:139], v[134:135], v[220:221] op_sel:[0,0] op_sel_hi:[0,1]
    v_pk_fma_f32 v[138:139], v[134:135], v[220:221], v[138:139] op_sel:[1,1,0] op_sel_hi:[1,0,1] neg_lo:[1,0,0]
    ds_write_b128 v53, v[172:175] offset:8192
    v_pk_mul_f32 v[140:141], v[136:137], v[220:221] op_sel:[0,0] op_sel_hi:[0,1]
    v_pk_fma_f32 v[140:141], v[136:137], v[220:221], v[140:141] op_sel:[1,1,0] op_sel_hi:[1,0,1] neg_lo:[1,0,0]
    v_pk_mul_f32 v[142:143], v[138:139], v[220:221] op_sel:[0,0] op_sel_hi:[0,1]
    v_pk_fma_f32 v[142:143], v[138:139], v[220:221], v[142:143] op_sel:[1,1,0] op_sel_hi:[1,0,1] neg_lo:[1,0,0]
    v_cvt_pk_bf16_f32 v160, v128, v130
    v_cvt_pk_bf16_f32 v161, v132, v134
    v_cvt_pk_bf16_f32 v162, v136, v138
    v_cvt_pk_bf16_f32 v163, v140, v142
    v_cvt_pk_bf16_f32 v164, v129, v131
    v_cvt_pk_bf16_f32 v165, v133, v135
    v_cvt_pk_bf16_f32 v166, v137, v139
    v_cvt_pk_bf16_f32 v167, v141, v143
    v_pk_mul_f32 v[144:145], v[140:141], v[220:221] op_sel:[0,0] op_sel_hi:[0,1]
    ds_write_b128 v50, v[160:163] offset:8192
    v_pk_fma_f32 v[144:145], v[140:141], v[220:221], v[144:145] op_sel:[1,1,0] op_sel_hi:[1,0,1] neg_lo:[1,0,0]
    v_pk_mul_f32 v[146:147], v[142:143], v[220:221] op_sel:[0,0] op_sel_hi:[0,1]
    v_pk_fma_f32 v[146:147], v[142:143], v[220:221], v[146:147] op_sel:[1,1,0] op_sel_hi:[1,0,1] neg_lo:[1,0,0]
    v_pk_mul_f32 v[148:149], v[144:145], v[220:221] op_sel:[0,0] op_sel_hi:[0,1]
    v_pk_fma_f32 v[148:149], v[144:145], v[220:221], v[148:149] op_sel:[1,1,0] op_sel_hi:[1,0,1] neg_lo:[1,0,0]
    v_pk_mul_f32 v[150:151], v[146:147], v[220:221] op_sel:[0,0] op_sel_hi:[0,1]
    v_pk_fma_f32 v[150:151], v[146:147], v[220:221], v[150:151] op_sel:[1,1,0] op_sel_hi:[1,0,1] neg_lo:[1,0,0]
    v_pk_mul_f32 v[152:153], v[148:149], v[220:221] op_sel:[0,0] op_sel_hi:[0,1]
    v_pk_fma_f32 v[152:153], v[148:149], v[220:221], v[152:153] op_sel:[1,1,0] op_sel_hi:[1,0,1] neg_lo:[1,0,0]
    v_pk_mul_f32 v[154:155], v[150:151], v[220:221] op_sel:[0,0] op_sel_hi:[0,1]
    v_pk_fma_f32 v[154:155], v[150:151], v[220:221], v[154:155] op_sel:[1,1,0] op_sel_hi:[1,0,1] neg_lo:[1,0,0]
    v_pk_mul_f32 v[156:157], v[152:153], v[220:221] op_sel:[0,0] op_sel_hi:[0,1]
    v_pk_fma_f32 v[156:157], v[152:153], v[220:221], v[156:157] op_sel:[1,1,0] op_sel_hi:[1,0,1] neg_lo:[1,0,0]
    ds_write_b128 v54, v[164:167] offset:8192
    v_pk_mul_f32 v[158:159], v[154:155], v[220:221] op_sel:[0,0] op_sel_hi:[0,1]
    v_pk_fma_f32 v[158:159], v[154:155], v[220:221], v[158:159] op_sel:[1,1,0] op_sel_hi:[1,0,1] neg_lo:[1,0,0]
    v_cvt_pk_bf16_f32 v168, v144, v146
    v_cvt_pk_bf16_f32 v169, v148, v150
    v_cvt_pk_bf16_f32 v170, v152, v154
    v_cvt_pk_bf16_f32 v171, v156, v158
    v_cvt_pk_bf16_f32 v172, v145, v147
    v_cvt_pk_bf16_f32 v173, v149, v151
    v_cvt_pk_bf16_f32 v174, v153, v155
    v_cvt_pk_bf16_f32 v175, v157, v159
    ds_write_b128 v51, v[168:171] offset:8192
    ds_write_b128 v55, v[172:175] offset:8192
    ds_read_b64_tr_b16 a[0:1], v56 offset:16384
    ds_read_b64_tr_b16 a[4:5], v56 offset:8192
    ds_read_b64_tr_b16 a[2:3], v57 offset:16384
    ds_read_b64_tr_b16 a[6:7], v57 offset:8192
    ds_read_b64_tr_b16 a[8:9], v56 offset:17408
    ds_read_b64_tr_b16 a[12:13], v56 offset:9216
    ds_read_b64_tr_b16 a[10:11], v57 offset:17408
    ds_read_b64_tr_b16 a[14:15], v57 offset:9216
    ds_read_b64_tr_b16 a[16:17], v56 offset:18432
    ds_read_b64_tr_b16 a[20:21], v56 offset:10240
    ds_read_b64_tr_b16 a[18:19], v57 offset:18432
    ds_read_b64_tr_b16 a[22:23], v57 offset:10240
    ds_read_b64_tr_b16 a[24:25], v56 offset:19456
    ds_read_b64_tr_b16 a[28:29], v56 offset:11264
    ds_read_b64_tr_b16 a[26:27], v57 offset:19456
    ds_read_b64_tr_b16 a[30:31], v57 offset:11264
    ds_read_b64_tr_b16 a[32:33], v56 offset:20480
    ds_read_b64_tr_b16 a[36:37], v56 offset:12288
    ds_read_b64_tr_b16 a[34:35], v57 offset:20480
    ds_read_b64_tr_b16 a[38:39], v57 offset:12288
    ds_read_b64_tr_b16 a[40:41], v56 offset:21504
    ds_read_b64_tr_b16 a[44:45], v56 offset:13312
    ds_read_b64_tr_b16 a[42:43], v57 offset:21504
    ds_read_b64_tr_b16 a[46:47], v57 offset:13312
    ds_read_b64_tr_b16 a[48:49], v56 offset:22528
    ds_read_b64_tr_b16 a[52:53], v56 offset:14336
    ds_read_b64_tr_b16 a[50:51], v57 offset:22528
    ds_read_b64_tr_b16 a[54:55], v57 offset:14336
    ds_read_b64_tr_b16 a[56:57], v56 offset:23552
    ds_read_b64_tr_b16 a[60:61], v56 offset:15360
    ds_read_b64_tr_b16 a[58:59], v57 offset:23552
    ds_read_b64_tr_b16 a[62:63], v57 offset:15360
    v_mfma_f32_32x32x16_bf16 v[80:95], a[0:3], a[4:7], 0
    v_mfma_f32_32x32x16_bf16 v[80:95], a[8:11], a[12:15], v[80:95]
    v_mfma_f32_32x32x16_bf16 v[80:95], a[16:19], a[20:23], v[80:95]
    v_mfma_f32_32x32x16_bf16 v[80:95], a[24:27], a[28:31], v[80:95]
    s_waitcnt lgkmcnt(12)
    v_mfma_f32_32x32x16_bf16 v[80:95], a[32:35], a[36:39], v[80:95]
    s_waitcnt lgkmcnt(8)
    v_mfma_f32_32x32x16_bf16 v[80:95], a[40:43], a[44:47], v[80:95]
    s_waitcnt lgkmcnt(4)
    v_mfma_f32_32x32x16_bf16 v[80:95], a[48:51], a[52:55], v[80:95]
    s_waitcnt lgkmcnt(0)
    v_mfma_f32_32x32x16_bf16 v[80:95], a[56:59], a[60:63], v[80:95]
    s_waitcnt vmcnt(3)
    v_xor_b32 v5, s71, v33
    v_xor_b32 v6, s71, v35
    v_or_b32 v5, v5, v6
    s_waitcnt vmcnt(2)
    v_xor_b32 v6, s71, v37
    v_or_b32 v5, v5, v6
    v_xor_b32 v6, s71, v39
    v_or_b32 v5, v5, v6
    s_waitcnt vmcnt(1)
    v_xor_b32 v6, s71, v41
    v_or_b32 v5, v5, v6
    v_xor_b32 v6, s71, v43
    v_or_b32 v5, v5, v6
    s_waitcnt vmcnt(0)
    v_xor_b32 v6, s71, v45
    v_or_b32 v5, v5, v6
    v_xor_b32 v6, s71, v47
    v_or_b32 v5, v5, v6
    v_cmp_ne_u32 vcc, 0, v5
    s_mov_b32 s79, 0
    s_nop 2
    s_cmp_eq_u64 vcc, 0
    s_cbranch_scc0 sequential_preLN__ssm_conv_s4d__glu_gated_swiglu__prompt_kernel_late8
    s_mov_b32 s79, 1
    s_movk_i32 s52, 7168
    v_mul_u32_u24 v4, s52, v0
    s_lshl_b32 s52, s70, 5
    s_add_u32 s52, s52, 0
    buffer_load_dwordx4 v[8:11], v4, s[32:35], s52 offen offset:0 sc1
    buffer_load_dwordx4 v[12:15], v4, s[32:35], s52 offen offset:16 sc1
sequential_preLN__ssm_conv_s4d__glu_gated_swiglu__prompt_kernel_late8:
    v_add_u32 v7, s77, v2
    ds_write_b128 v7, v[64:67] offset:0
    ds_write_b128 v7, v[68:71] offset:1024
    ds_write_b128 v7, v[72:75] offset:2048
    ds_write_b128 v7, v[76:79] offset:3072
    ds_write_b128 v7, v[80:83] offset:4096
    ds_write_b128 v7, v[84:87] offset:5120
    ds_write_b128 v7, v[88:91] offset:6144
    ds_write_b128 v7, v[92:95] offset:7168
    s_lshl_b32 s63, s3, 10
    s_add_u32 s63, s63, 49152
    v_add_u32 v7, s63, v2
    v_add_u32 v5, 49152, v7
    v_and_b32 v6, 31, v1
    v_lshlrev_b32 v6, 4, v6
    v_lshl_add_u32 v6, v3, 3, v6
    s_waitcnt lgkmcnt(0)
    s_barrier
    ds_read_b128 v[96:99], v7 offset:0
    ds_read_b128 v[100:103], v7 offset:24576
    ds_read_b128 v[104:107], v5 offset:0
    ds_read_b128 v[108:111], v5 offset:24576
    ds_read_b128 v[112:115], v7 offset:4096
    ds_read_b128 v[116:119], v7 offset:28672
    ds_read_b128 v[120:123], v5 offset:4096
    ds_read_b128 v[124:127], v5 offset:28672
    s_waitcnt lgkmcnt(6)
    v_pk_add_f32 v[96:97], v[96:97], v[100:101]
    s_waitcnt lgkmcnt(4)
    v_pk_add_f32 v[104:105], v[104:105], v[108:109]
    v_pk_add_f32 v[98:99], v[98:99], v[102:103]
    v_pk_add_f32 v[106:107], v[106:107], v[110:111]
    v_pk_add_f32 v[96:97], v[96:97], v[104:105]
    v_pk_add_f32 v[98:99], v[98:99], v[106:107]
    s_waitcnt lgkmcnt(2)
    v_pk_add_f32 v[112:113], v[112:113], v[116:117]
    s_waitcnt lgkmcnt(0)
    v_pk_add_f32 v[120:121], v[120:121], v[124:125]
    v_pk_add_f32 v[114:115], v[114:115], v[118:119]
    v_pk_add_f32 v[122:123], v[122:123], v[126:127]
    v_pk_add_f32 v[112:113], v[112:113], v[120:121]
    v_pk_add_f32 v[114:115], v[114:115], v[122:123]
    s_cmp_eq_u32 s3, 1
    s_cbranch_scc1 sequential_preLN__ssm_conv_s4d__glu_gated_swiglu__prompt_kernel_seg10
    s_cmp_eq_u32 s3, 2
    s_cbranch_scc1 sequential_preLN__ssm_conv_s4d__glu_gated_swiglu__prompt_kernel_seg11
    s_cmp_eq_u32 s3, 3
    s_cbranch_scc1 sequential_preLN__ssm_conv_s4d__glu_gated_swiglu__prompt_kernel_seg12
    v_cvt_pk_bf16_f32 v208, v96, v97
    v_cvt_pk_bf16_f32 v209, v98, v99
    ds_write_b64 v6, v[208:209] offset:128
    v_cvt_pk_bf16_f32 v210, v112, v113
    v_cvt_pk_bf16_f32 v211, v114, v115
    ds_write_b64 v6, v[210:211] offset:16800
    s_waitcnt lgkmcnt(0)
    s_branch sequential_preLN__ssm_conv_s4d__glu_gated_swiglu__prompt_kernel_segend13
sequential_preLN__ssm_conv_s4d__glu_gated_swiglu__prompt_kernel_seg10:
    v_cvt_pk_bf16_f32 v208, v96, v96
    v_cvt_pk_bf16_f32 v209, v97, v98
    ds_write_b64 v6, v[208:209] offset:640
    v_cvt_pk_bf16_f32 v210, v112, v112
    v_cvt_pk_bf16_f32 v211, v113, v114
    ds_write_b64 v6, v[210:211] offset:17312
    s_waitcnt lgkmcnt(0)
    s_branch sequential_preLN__ssm_conv_s4d__glu_gated_swiglu__prompt_kernel_segend13
sequential_preLN__ssm_conv_s4d__glu_gated_swiglu__prompt_kernel_seg11:
    v_cmp_lt_u32 vcc, 31, v1
    s_nop 1
    v_cndmask_b32 v216, v96, v97, vcc
    v_cvt_pk_bf16_f32 v208, v96, v96
    v_cvt_pk_bf16_f32 v209, v216, v97
    ds_write_b64 v6, v[208:209] offset:1152
    v_cndmask_b32 v217, v98, v99, vcc
    v_cvt_pk_bf16_f32 v210, v98, v98
    v_cvt_pk_bf16_f32 v211, v217, v99
    ds_write_b64 v6, v[210:211] offset:1664
    v_cndmask_b32 v218, v112, v113, vcc
    v_cvt_pk_bf16_f32 v212, v112, v112
    v_cvt_pk_bf16_f32 v213, v218, v113
    ds_write_b64 v6, v[212:213] offset:17824
    v_cndmask_b32 v219, v114, v115, vcc
    v_cvt_pk_bf16_f32 v214, v114, v114
    v_cvt_pk_bf16_f32 v215, v219, v115
    ds_write_b64 v6, v[214:215] offset:18336
    s_waitcnt lgkmcnt(0)
    s_branch sequential_preLN__ssm_conv_s4d__glu_gated_swiglu__prompt_kernel_segend13
sequential_preLN__ssm_conv_s4d__glu_gated_swiglu__prompt_kernel_seg12:
    v_cvt_pk_bf16_f32 v208, v96, v96
    v_mov_b32_e64 v209, v208
    ds_write_b64 v6, v[208:209] offset:2176
    v_cvt_pk_bf16_f32 v210, v97, v97
    v_mov_b32_e64 v211, v210
    ds_write_b64 v6, v[210:211] offset:2688
    v_cvt_pk_bf16_f32 v212, v98, v98
    v_mov_b32_e64 v213, v212
    ds_write_b64 v6, v[212:213] offset:3200
    v_cvt_pk_bf16_f32 v214, v99, v99
    v_mov_b32_e64 v215, v214
    ds_write_b64 v6, v[214:215] offset:3712
    v_cvt_pk_bf16_f32 v216, v112, v112
    v_mov_b32_e64 v217, v216
    ds_write_b64 v6, v[216:217] offset:18848
    v_cvt_pk_bf16_f32 v218, v113, v113
    v_mov_b32_e64 v219, v218
    ds_write_b64 v6, v[218:219] offset:19360
    v_cvt_pk_bf16_f32 v220, v114, v114
    v_mov_b32_e64 v221, v220
    ds_write_b64 v6, v[220:221] offset:19872
    v_cvt_pk_bf16_f32 v222, v115, v115
    v_mov_b32_e64 v223, v222
    ds_write_b64 v6, v[222:223] offset:20384
    s_mov_b32 exec_lo, 0x55555555
    s_mov_b32 exec_hi, 0
    ds_write_b16 v6, v208 offset:2184
    ds_write_b16 v6, v210 offset:2696
    ds_write_b16 v6, v212 offset:3208
    ds_write_b16 v6, v214 offset:3720
    ds_write_b16 v6, v216 offset:18856
    ds_write_b16 v6, v218 offset:19368
    ds_write_b16 v6, v220 offset:19880
    ds_write_b16 v6, v222 offset:20392
    s_mov_b64 exec, -1
    s_waitcnt lgkmcnt(0)
sequential_preLN__ssm_conv_s4d__glu_gated_swiglu__prompt_kernel_segend13:
    s_barrier
    v_lshlrev_b32_e64 v6, 4, v0
    ds_read_b64 v[96:97], v6 offset:120
    ds_read_b128 v[98:101], v6 offset:128
    ds_read_b64 v[120:121], v6 offset:16792
    ds_read_b128 v[122:125], v6 offset:16800
    s_waitcnt lgkmcnt(3)
    v_alignbit_b32 v104, v97, v96, 16
    s_waitcnt lgkmcnt(2)
    v_alignbit_b32 v105, v98, v97, 16
    v_alignbit_b32 v106, v99, v98, 16
    v_alignbit_b32 v107, v100, v99, 16
    ds_write_b128 v6, v[104:107] offset:4288
    v_pk_mov_b32 v[112:113], v[96:97], v[98:99] op_sel:[1,0]
    v_pk_mov_b32 v[114:115], v[98:99], v[100:101] op_sel:[1,0]
    ds_write_b128 v6, v[112:115] offset:8448
    v_alignbit_b32 v108, v98, v97, 16
    v_alignbit_b32 v109, v99, v98, 16
    v_alignbit_b32 v110, v100, v99, 16
    v_alignbit_b32 v111, v101, v100, 16
    ds_write_b128 v6, v[108:111] offset:12608
    s_waitcnt lgkmcnt(4)
    v_alignbit_b32 v128, v121, v120, 16
    s_waitcnt lgkmcnt(3)
    v_alignbit_b32 v129, v122, v121, 16
    v_alignbit_b32 v130, v123, v122, 16
    v_alignbit_b32 v131, v124, v123, 16
    ds_write_b128 v6, v[128:131] offset:20960
    v_pk_mov_b32 v[136:137], v[120:121], v[122:123] op_sel:[1,0]
    v_pk_mov_b32 v[138:139], v[122:123], v[124:125] op_sel:[1,0]
    ds_write_b128 v6, v[136:139] offset:25120
    v_alignbit_b32 v132, v122, v121, 16
    v_alignbit_b32 v133, v123, v122, 16
    v_alignbit_b32 v134, v124, v123, 16
    v_alignbit_b32 v135, v125, v124, 16
    ds_write_b128 v6, v[132:135] offset:29280
    s_waitcnt lgkmcnt(0)
    s_cmp_eq_u32 s79, 1
    s_cbranch_scc1 sequential_preLN__ssm_conv_s4d__glu_gated_swiglu__prompt_kernel_havex14
    v_lshlrev_b32 v4, 7, v0
    s_mov_b32 s53, 17809408
    buffer_load_dwordx4 v[32:35], v4, s[32:35], s53 offen offset:0 sc1
    buffer_load_dwordx4 v[36:39], v4, s[32:35], s53 offen offset:16 sc1
    buffer_load_dwordx4 v[40:43], v4, s[32:35], s53 offen offset:32 sc1
    buffer_load_dwordx4 v[44:47], v4, s[32:35], s53 offen offset:48 sc1
    s_mov_b32 s52, 0
    s_waitcnt vmcnt(0)
    v_mov_b32_e64 v4, v47
sequential_preLN__ssm_conv_s4d__glu_gated_swiglu__prompt_kernel_glp16:
    v_xor_b32 v5, s71, v33
    v_xor_b32 v6, s71, v35
    v_or_b32 v5, v5, v6
    v_xor_b32 v6, s71, v37
    v_or_b32 v5, v5, v6
    v_xor_b32 v6, s71, v39
    v_or_b32 v5, v5, v6
    v_xor_b32 v6, s71, v41
    v_or_b32 v5, v5, v6
    v_xor_b32 v6, s71, v43
    v_or_b32 v5, v5, v6
    v_xor_b32 v6, s71, v45
    v_or_b32 v5, v5, v6
    v_xor_b32 v6, s71, v47
    v_or_b32 v5, v5, v6
    v_cmp_ne_u32 vcc, 0, v5
    s_add_u32 s52, s52, 1
    s_nop 2
    s_cmp_eq_u64 vcc, 0
    s_cbranch_scc1 sequential_preLN__ssm_conv_s4d__glu_gated_swiglu__prompt_kernel_gok15
    s_cmp_ge_u32 s52, 400000
    s_cbranch_scc1 sequential_preLN__ssm_conv_s4d__glu_gated_swiglu__prompt_kernel_gok15
    v_lshlrev_b32 v4, 7, v0
    s_mov_b32 s53, 17809408
    buffer_load_dwordx4 v[32:35], v4, s[32:35], s53 offen offset:0 sc1
    buffer_load_dwordx4 v[36:39], v4, s[32:35], s53 offen offset:16 sc1
    buffer_load_dwordx4 v[40:43], v4, s[32:35], s53 offen offset:32 sc1
    buffer_load_dwordx4 v[44:47], v4, s[32:35], s53 offen offset:48 sc1
    s_waitcnt vmcnt(0) lgkmcnt(0)
    s_branch sequential_preLN__ssm_conv_s4d__glu_gated_swiglu__prompt_kernel_glp16
sequential_preLN__ssm_conv_s4d__glu_gated_swiglu__prompt_kernel_gok15:
    s_movk_i32 s52, 7168
    v_mul_u32_u24 v4, s52, v0
    s_lshl_b32 s52, s70, 5
    s_add_u32 s52, s52, 0
    buffer_load_dwordx4 v[8:11], v4, s[32:35], s52 offen offset:0 sc1
    buffer_load_dwordx4 v[12:15], v4, s[32:35], s52 offen offset:16 sc1
sequential_preLN__ssm_conv_s4d__glu_gated_swiglu__prompt_kernel_havex14:
    s_waitcnt vmcnt(0)
    v_lshlrev_b32 v58, 16, v249
    v_and_b32 v59, 0xffff0000, v249
    v_and_b32 v104, 0xffff0000, v32
    v_lshlrev_b32_e64 v96, 16, v32
    v_and_b32 v105, 0xffff0000, v34
    v_lshlrev_b32_e64 v97, 16, v34
    v_and_b32 v106, 0xffff0000, v36
    v_lshlrev_b32_e64 v98, 16, v36
    v_and_b32 v107, 0xffff0000, v38
    v_lshlrev_b32_e64 v99, 16, v38
    v_and_b32 v108, 0xffff0000, v40
    v_lshlrev_b32_e64 v100, 16, v40
    v_and_b32 v109, 0xffff0000, v42
    v_lshlrev_b32_e64 v101, 16, v42
    v_and_b32 v110, 0xffff0000, v44
    v_lshlrev_b32_e64 v102, 16, v44
    v_and_b32 v111, 0xffff0000, v46
    v_lshlrev_b32 v103, 16, v46
    v_rcp_f32 v104, v104
    v_rcp_f32 v105, v105
    v_rcp_f32 v106, v106
    v_rcp_f32 v107, v107
    v_rcp_f32 v108, v108
    v_rcp_f32 v109, v109
    v_rcp_f32 v110, v110
    v_rcp_f32 v111, v111
    v_lshlrev_b32 v112, 16, v8
    v_and_b32 v113, 0xffff0000, v8
    v_pk_add_f32 v[114:115], v[112:113], v[96:97] neg_lo:[0,1] neg_hi:[0,1]
    v_cvt_pk_bf16_f32 v116, v114, v115
    v_lshlrev_b32_e64 v114, 16, v116
    v_and_b32 v115, 0xffff0000, v116
    v_pk_mul_f32 v[114:115], v[114:115], v[104:105]
    v_cvt_pk_bf16_f32 v155, v115, v114
    v_and_b32 v114, 0xffff0000, v155
    v_lshlrev_b32_e64 v115, 16, v155
    v_pk_mul_f32 v[114:115], v[114:115], v[58:59] op_sel:[0,0] op_sel_hi:[1,0]
    v_cvt_pk_bf16_f32 v136, v112, v114
    v_cvt_pk_bf16_f32 v137, v113, v115
    v_lshlrev_b32_e64 v118, 16, v9
    v_and_b32 v119, 0xffff0000, v9
    v_pk_add_f32 v[120:121], v[118:119], v[98:99] neg_lo:[0,1] neg_hi:[0,1]
    v_cvt_pk_bf16_f32 v122, v120, v121
    v_lshlrev_b32_e64 v120, 16, v122
    v_and_b32 v121, 0xffff0000, v122
    v_pk_mul_f32 v[120:121], v[120:121], v[106:107]
    v_cvt_pk_bf16_f32 v154, v121, v120
    v_and_b32 v120, 0xffff0000, v154
    v_lshlrev_b32_e64 v121, 16, v154
    v_pk_mul_f32 v[120:121], v[120:121], v[58:59] op_sel:[0,0] op_sel_hi:[1,0]
    v_cvt_pk_bf16_f32 v138, v118, v120
    v_cvt_pk_bf16_f32 v139, v119, v121
    v_lshlrev_b32_e64 v124, 16, v10
    v_and_b32 v125, 0xffff0000, v10
    v_pk_add_f32 v[126:127], v[124:125], v[100:101] neg_lo:[0,1] neg_hi:[0,1]
    v_cvt_pk_bf16_f32 v128, v126, v127
    v_lshlrev_b32_e64 v126, 16, v128
    v_and_b32 v127, 0xffff0000, v128
    v_pk_mul_f32 v[126:127], v[126:127], v[108:109]
    v_cvt_pk_bf16_f32 v153, v127, v126
    v_and_b32 v126, 0xffff0000, v153
    v_lshlrev_b32_e64 v127, 16, v153
    v_pk_mul_f32 v[126:127], v[126:127], v[58:59] op_sel:[0,0] op_sel_hi:[1,0]
    v_cvt_pk_bf16_f32 v140, v124, v126
    v_cvt_pk_bf16_f32 v141, v125, v127
    v_lshlrev_b32_e64 v130, 16, v11
    v_and_b32 v131, 0xffff0000, v11
    v_pk_add_f32 v[132:133], v[130:131], v[102:103] neg_lo:[0,1] neg_hi:[0,1]
    v_cvt_pk_bf16_f32 v134, v132, v133
    v_lshlrev_b32_e64 v132, 16, v134
    v_and_b32 v133, 0xffff0000, v134
    v_pk_mul_f32 v[132:133], v[132:133], v[110:111]
    v_cvt_pk_bf16_f32 v152, v133, v132
    v_and_b32 v132, 0xffff0000, v152
    v_lshlrev_b32_e64 v133, 16, v152
    v_pk_mul_f32 v[132:133], v[132:133], v[58:59] op_sel:[0,0] op_sel_hi:[1,0]
    v_cvt_pk_bf16_f32 v142, v130, v132
    v_cvt_pk_bf16_f32 v143, v131, v133
    v_lshlrev_b32_e64 v112, 16, v12
    v_and_b32 v113, 0xffff0000, v12
    v_pk_add_f32 v[114:115], v[112:113], v[96:97] neg_lo:[0,1] neg_hi:[0,1]
    v_cvt_pk_bf16_f32 v116, v114, v115
    v_lshlrev_b32_e64 v114, 16, v116
    v_and_b32 v115, 0xffff0000, v116
    v_pk_mul_f32 v[114:115], v[114:115], v[104:105]
    v_cvt_pk_bf16_f32 v159, v115, v114
    v_and_b32 v114, 0xffff0000, v159
    v_lshlrev_b32_e64 v115, 16, v159
    v_pk_mul_f32 v[114:115], v[114:115], v[58:59] op_sel:[0,1] op_sel_hi:[1,1]
    v_cvt_pk_bf16_f32 v144, v112, v114
    v_cvt_pk_bf16_f32 v145, v113, v115
    v_lshlrev_b32_e64 v118, 16, v13
    v_and_b32 v119, 0xffff0000, v13
    v_pk_add_f32 v[120:121], v[118:119], v[98:99] neg_lo:[0,1] neg_hi:[0,1]
    v_cvt_pk_bf16_f32 v122, v120, v121
    v_lshlrev_b32_e64 v120, 16, v122
    v_and_b32 v121, 0xffff0000, v122
    v_pk_mul_f32 v[120:121], v[120:121], v[106:107]
    v_cvt_pk_bf16_f32 v158, v121, v120
    v_and_b32 v120, 0xffff0000, v158
    v_lshlrev_b32_e64 v121, 16, v158
    v_pk_mul_f32 v[120:121], v[120:121], v[58:59] op_sel:[0,1] op_sel_hi:[1,1]
    v_cvt_pk_bf16_f32 v146, v118, v120
    v_cvt_pk_bf16_f32 v147, v119, v121
    v_lshlrev_b32_e64 v124, 16, v14
    v_and_b32 v125, 0xffff0000, v14
    v_pk_add_f32 v[126:127], v[124:125], v[100:101] neg_lo:[0,1] neg_hi:[0,1]
    v_cvt_pk_bf16_f32 v128, v126, v127
    v_lshlrev_b32_e64 v126, 16, v128
    v_and_b32 v127, 0xffff0000, v128
    v_pk_mul_f32 v[126:127], v[126:127], v[108:109]
    v_cvt_pk_bf16_f32 v157, v127, v126
    v_and_b32 v126, 0xffff0000, v157
    v_lshlrev_b32_e64 v127, 16, v157
    v_pk_mul_f32 v[126:127], v[126:127], v[58:59] op_sel:[0,1] op_sel_hi:[1,1]
    v_cvt_pk_bf16_f32 v148, v124, v126
    v_cvt_pk_bf16_f32 v149, v125, v127
    v_lshlrev_b32_e64 v130, 16, v15
    v_and_b32 v131, 0xffff0000, v15
    v_pk_add_f32 v[132:133], v[130:131], v[102:103] neg_lo:[0,1] neg_hi:[0,1]
    v_cvt_pk_bf16_f32 v134, v132, v133
    v_lshlrev_b32_e64 v132, 16, v134
    v_and_b32 v133, 0xffff0000, v134
    v_pk_mul_f32 v[132:133], v[132:133], v[110:111]
    v_cvt_pk_bf16_f32 v156, v133, v132
    v_and_b32 v132, 0xffff0000, v156
    v_lshlrev_b32_e64 v133, 16, v156
    v_pk_mul_f32 v[132:133], v[132:133], v[58:59] op_sel:[0,1] op_sel_hi:[1,1]
    v_cvt_pk_bf16_f32 v150, v130, v132
    v_cvt_pk_bf16_f32 v151, v131, v133
    v_lshrrev_b32_e64 v5, 2, v0
    v_mul_u32_u24 v6, 80, v5
    v_and_b32_e64 v7, 3, v0
    v_lshl_add_u32 v6, v7, 4, v6
    v_mul_u32_u24 v5, 144, v5
    v_lshl_add_u32 v5, v7, 5, v5
    v_add_u32 v5, 81920, v5
    ds_write_b128 v6, v[152:155] offset:35968
    ds_write_b128 v6, v[156:159] offset:43648
    ds_write_b128 v5, v[136:139] offset:0
    ds_write_b128 v5, v[140:143] offset:16
    ds_write_b128 v5, v[144:147] offset:9216
    ds_write_b128 v5, v[148:151] offset:9232
    s_lshr_b32 s63, s3, 1
    s_and_b32 s64, s3, 1
    v_and_b32 v224, 31, v1
    v_add_u32 v225, 1, v224
    v_and_b32 v225, 3, v225
    v_add_u32 v226, 25, v224
    v_sub_u32 v226, v226, v225
    v_lshlrev_b32 v226, 1, v226
    v_mul_u32_u24 v227, 4160, v225
    v_add_u32 v226, v226, v227
    v_min_u32 v227, 1, v225
    v_lshl_add_u32 v226, v227, 3, v226
    v_lshlrev_b32 v227, 4, v3
    v_sub_u32 v226, v226, v227
    s_mul_i32 s65, s63, 16672
    s_add_u32 s65, s65, 32
    s_lshl_b32 s66, s64, 10
    s_add_u32 s65, s65, s66
    v_add_u32 v6, s65, v226
    v_mul_u32_u24 v226, 80, v224
    v_add_u32_e64 v226, v226, v227
    s_mul_i32 s65, s63, 7680
    s_add_u32 s65, s65, 33408
    s_mul_i32 s66, s64, 1280
    s_sub_u32 s65, s65, s66
    v_add_u32 v7, s65, v226
    s_waitcnt lgkmcnt(0)
    s_barrier
    s_mov_b32 s68, 0xffff0000
    v_and_b32_e64 v4, 31, v1
    v_mul_u32_u24 v4, 144, v4
    v_lshl_add_u32 v4, v3, 4, v4
    s_mul_i32 s65, s63, 9216
    s_mul_i32 s66, s64, 4608
    s_add_u32 s65, s65, s66
    s_add_u32 s65, s65, 81920
    v_add_u32 v4, s65, v4
    ds_read_b128 v[32:35], v4 offset:0
    ds_read_b128 v[36:39], v4 offset:32
    ds_read_b128 v[40:43], v4 offset:64
    ds_read_b128 v[44:47], v4 offset:96
    ds_read_b64 v[96:97], v6 offset:32
    ds_read_b64 v[98:99], v6 offset:40
    ds_read_b128 v[100:103], v7 offset:2560
    ds_read_b64 v[104:105], v6 offset:2080
    ds_read_b64 v[106:107], v6 offset:2088
    ds_read_b64 v[108:109], v6 offset:0
    ds_read_b64 v[110:111], v6 offset:8
    ds_read_b128 v[112:115], v7 offset:2592
    ds_read_b64 v[116:117], v6 offset:2048
    ds_read_b64 v[118:119], v6 offset:2056
    s_waitcnt lgkmcnt(7)
    v_mfma_f32_32x32x16_bf16 v[64:79], v[96:99], v[100:103], 0
    ds_read_b64 v[120:121], v6 offset:96
    ds_read_b64 v[122:123], v6 offset:104
    s_waitcnt lgkmcnt(7)
    v_mfma_f32_32x32x16_bf16 v[80:95], v[104:107], v[100:103], 0
    ds_read_b128 v[124:127], v7 offset:2480
    ds_read_b64 v[128:129], v6 offset:2144
    ds_read_b64 v[130:131], v6 offset:2152
    s_waitcnt lgkmcnt(7)
    v_mfma_f32_32x32x16_bf16 v[64:79], v[108:111], v[112:115], v[64:79]
    ds_read_b64 v[132:133], v6 offset:64
    ds_read_b64 v[134:135], v6 offset:72
    s_waitcnt lgkmcnt(7)
    v_mfma_f32_32x32x16_bf16 v[80:95], v[116:119], v[112:115], v[80:95]
    ds_read_b128 v[136:139], v7 offset:2512
    ds_read_b64 v[140:141], v6 offset:2112
    ds_read_b64 v[142:143], v6 offset:2120
    s_waitcnt lgkmcnt(7)
    v_mfma_f32_32x32x16_bf16 v[64:79], v[120:123], v[124:127], v[64:79]
    ds_read_b64 v[96:97], v6 offset:160
    ds_read_b64 v[98:99], v6 offset:168
    s_waitcnt lgkmcnt(7)
    v_mfma_f32_32x32x16_bf16 v[80:95], v[128:131], v[124:127], v[80:95]
    ds_write_b128 v252, v[16:19] offset:0
    ds_read_b128 v[100:103], v7 offset:2400
    ds_read_b64 v[104:105], v6 offset:2208
    ds_read_b64 v[106:107], v6 offset:2216
    s_waitcnt lgkmcnt(8)
    v_mfma_f32_32x32x16_bf16 v[64:79], v[132:135], v[136:139], v[64:79]
    ds_write_b128 v252, v[20:23] offset:512
    ds_read_b64 v[108:109], v6 offset:128
    ds_read_b64 v[110:111], v6 offset:136
    s_waitcnt lgkmcnt(9)
    v_mfma_f32_32x32x16_bf16 v[80:95], v[140:143], v[136:139], v[80:95]
    ds_write_b128 v252, v[24:27] offset:2176
    ds_read_b128 v[112:115], v7 offset:2432
    ds_read_b64 v[116:117], v6 offset:2176
    ds_read_b64 v[118:119], v6 offset:2184
    s_waitcnt lgkmcnt(9)
    v_mfma_f32_32x32x16_bf16 v[64:79], v[96:99], v[100:103], v[64:79]
    ds_write_b128 v252, v[28:31] offset:2688
    ds_read_b64 v[120:121], v6 offset:224
    ds_read_b64 v[122:123], v6 offset:232
    s_waitcnt lgkmcnt(10)
    v_mfma_f32_32x32x16_bf16 v[80:95], v[104:107], v[100:103], v[80:95]
    ds_read_b64_tr_b16 v[48:49], v253 offset:0
    ds_read_b128 v[124:127], v7 offset:2320
    ds_read_b64 v[128:129], v6 offset:2272
    ds_read_b64 v[130:131], v6 offset:2280
    s_waitcnt lgkmcnt(9)
    v_mfma_f32_32x32x16_bf16 v[64:79], v[108:111], v[112:115], v[64:79]
    ds_read_b64_tr_b16 v[50:51], v253 offset:256
    ds_read_b64 v[132:133], v6 offset:192
    ds_read_b64 v[134:135], v6 offset:200
    s_waitcnt lgkmcnt(10)
    v_mfma_f32_32x32x16_bf16 v[80:95], v[116:119], v[112:115], v[80:95]
    ds_read_b64_tr_b16 v[52:53], v253 offset:1088
    ds_read_b128 v[136:139], v7 offset:2352
    ds_read_b64 v[140:141], v6 offset:2240
    ds_read_b64 v[142:143], v6 offset:2248
    s_waitcnt lgkmcnt(9)
    v_mfma_f32_32x32x16_bf16 v[64:79], v[120:123], v[124:127], v[64:79]
    ds_read_b64_tr_b16 v[54:55], v253 offset:1344
    ds_read_b64 v[96:97], v6 offset:288
    ds_read_b64 v[98:99], v6 offset:296
    s_waitcnt lgkmcnt(10)
    v_mfma_f32_32x32x16_bf16 v[80:95], v[128:131], v[124:127], v[80:95]
    ds_read_b64_tr_b16 v[56:57], v254 offset:2176
    ds_read_b128 v[100:103], v7 offset:2240
    ds_read_b64 v[104:105], v6 offset:2336
    ds_read_b64 v[106:107], v6 offset:2344
    s_waitcnt lgkmcnt(9)
    v_mfma_f32_32x32x16_bf16 v[64:79], v[132:135], v[136:139], v[64:79]
    ds_read_b64_tr_b16 v[58:59], v251 offset:2176
    ds_read_b64 v[108:109], v6 offset:256
    ds_read_b64 v[110:111], v6 offset:264
    s_waitcnt lgkmcnt(10)
    v_mfma_f32_32x32x16_bf16 v[80:95], v[140:143], v[136:139], v[80:95]
    ds_read_b64_tr_b16 v[60:61], v254 offset:3264
    ds_read_b128 v[112:115], v7 offset:2272
    ds_read_b64 v[116:117], v6 offset:2304
    ds_read_b64 v[118:119], v6 offset:2312
    s_waitcnt lgkmcnt(9)
    v_mfma_f32_32x32x16_bf16 v[64:79], v[96:99], v[100:103], v[64:79]
    ds_read_b64_tr_b16 v[62:63], v251 offset:3264
    ds_read_b64 v[120:121], v6 offset:352
    ds_read_b64 v[122:123], v6 offset:360
    s_waitcnt lgkmcnt(10)
    v_mfma_f32_32x32x16_bf16 v[80:95], v[104:107], v[100:103], v[80:95]
    buffer_store_dwordx4 v[48:51], v2, s[32:35], s72 offen sc1
    ds_read_b128 v[124:127], v7 offset:2160
    ds_read_b64 v[128:129], v6 offset:2400
    ds_read_b64 v[130:131], v6 offset:2408
    s_waitcnt lgkmcnt(8)
    v_mfma_f32_32x32x16_bf16 v[64:79], v[108:111], v[112:115], v[64:79]
    buffer_store_dwordx4 v[52:55], v2, s[32:35], s74 offen sc1
    ds_read_b64 v[132:133], v6 offset:320
    ds_read_b64 v[134:135], v6 offset:328
    s_waitcnt lgkmcnt(8)
    v_mfma_f32_32x32x16_bf16 v[80:95], v[116:119], v[112:115], v[80:95]
    buffer_store_dwordx4 v[56:59], v2, s[32:35], s73 offen sc1
    ds_read_b128 v[136:139], v7 offset:2192
    ds_read_b64 v[140:141], v6 offset:2368
    ds_read_b64 v[142:143], v6 offset:2376
    s_waitcnt lgkmcnt(7)
    v_mfma_f32_32x32x16_bf16 v[64:79], v[120:123], v[124:127], v[64:79]
    buffer_store_dwordx4 v[60:63], v2, s[32:35], s75 offen sc1
    ds_read_b64 v[96:97], v6 offset:416
    ds_read_b64 v[98:99], v6 offset:424
    s_waitcnt lgkmcnt(7)
    v_mfma_f32_32x32x16_bf16 v[80:95], v[128:131], v[124:127], v[80:95]
    v_and_b32 v160, 0xffff0000, v32
    ds_read_b128 v[100:103], v7 offset:2080
    ds_read_b64 v[104:105], v6 offset:2464
    ds_read_b64 v[106:107], v6 offset:2472
    s_waitcnt lgkmcnt(7)
    v_mfma_f32_32x32x16_bf16 v[64:79], v[132:135], v[136:139], v[64:79]
    v_lshlrev_b32 v176, 16, v32
    ds_read_b64 v[108:109], v6 offset:384
    ds_read_b64 v[110:111], v6 offset:392
    s_waitcnt lgkmcnt(7)
    v_mfma_f32_32x32x16_bf16 v[80:95], v[140:143], v[136:139], v[80:95]
    v_and_b32 v161, 0xffff0000, v33
    ds_read_b128 v[112:115], v7 offset:2112
    ds_read_b64 v[116:117], v6 offset:2432
    ds_read_b64 v[118:119], v6 offset:2440
    s_waitcnt lgkmcnt(7)
    v_mfma_f32_32x32x16_bf16 v[64:79], v[96:99], v[100:103], v[64:79]
    v_lshlrev_b32_e64 v177, 16, v33
    ds_read_b64 v[120:121], v6 offset:480
    ds_read_b64 v[122:123], v6 offset:488
    s_waitcnt lgkmcnt(7)
    v_mfma_f32_32x32x16_bf16 v[80:95], v[104:107], v[100:103], v[80:95]
    v_and_b32 v162, 0xffff0000, v34
    ds_read_b128 v[124:127], v7 offset:2000
    ds_read_b64 v[128:129], v6 offset:2528
    ds_read_b64 v[130:131], v6 offset:2536
    s_waitcnt lgkmcnt(7)
    v_mfma_f32_32x32x16_bf16 v[64:79], v[108:111], v[112:115], v[64:79]
    v_lshlrev_b32_e64 v178, 16, v34
    ds_read_b64 v[132:133], v6 offset:448
    ds_read_b64 v[134:135], v6 offset:456
    s_waitcnt lgkmcnt(7)
    v_mfma_f32_32x32x16_bf16 v[80:95], v[116:119], v[112:115], v[80:95]
    v_and_b32 v163, 0xffff0000, v35
    ds_read_b128 v[136:139], v7 offset:2032
    ds_read_b64 v[140:141], v6 offset:2496
    ds_read_b64 v[142:143], v6 offset:2504
    s_waitcnt lgkmcnt(7)
    v_mfma_f32_32x32x16_bf16 v[64:79], v[120:123], v[124:127], v[64:79]
    ds_read_b64 v[96:97], v6 offset:544
    ds_read_b64 v[98:99], v6 offset:552
    s_waitcnt lgkmcnt(7)
    v_mfma_f32_32x32x16_bf16 v[80:95], v[128:131], v[124:127], v[80:95]
    v_lshlrev_b32 v179, 16, v35
    ds_read_b128 v[100:103], v7 offset:1920
    ds_read_b64 v[104:105], v6 offset:2592
    ds_read_b64 v[106:107], v6 offset:2600
    s_waitcnt lgkmcnt(7)
    v_mfma_f32_32x32x16_bf16 v[64:79], v[132:135], v[136:139], v[64:79]
    v_and_b32 v164, 0xffff0000, v36
    ds_read_b64 v[108:109], v6 offset:512
    ds_read_b64 v[110:111], v6 offset:520
    s_waitcnt lgkmcnt(7)
    v_mfma_f32_32x32x16_bf16 v[80:95], v[140:143], v[136:139], v[80:95]
    v_lshlrev_b32_e64 v180, 16, v36
    ds_read_b128 v[112:115], v7 offset:1952
    ds_read_b64 v[116:117], v6 offset:2560
    ds_read_b64 v[118:119], v6 offset:2568
    s_waitcnt lgkmcnt(7)
    v_mfma_f32_32x32x16_bf16 v[64:79], v[96:99], v[100:103], v[64:79]
    v_and_b32 v165, 0xffff0000, v37
    ds_read_b64 v[120:121], v6 offset:608
    ds_read_b64 v[122:123], v6 offset:616
    s_waitcnt lgkmcnt(7)
    v_mfma_f32_32x32x16_bf16 v[80:95], v[104:107], v[100:103], v[80:95]
    v_lshlrev_b32_e64 v181, 16, v37
    ds_read_b128 v[124:127], v7 offset:1840
    ds_read_b64 v[128:129], v6 offset:2656
    ds_read_b64 v[130:131], v6 offset:2664
    s_waitcnt lgkmcnt(7)
    v_mfma_f32_32x32x16_bf16 v[64:79], v[108:111], v[112:115], v[64:79]
    v_and_b32 v166, 0xffff0000, v38
    ds_read_b64 v[132:133], v6 offset:576
    ds_read_b64 v[134:135], v6 offset:584
    s_waitcnt lgkmcnt(7)
    v_mfma_f32_32x32x16_bf16 v[80:95], v[116:119], v[112:115], v[80:95]
    v_lshlrev_b32_e64 v182, 16, v38
    ds_read_b128 v[136:139], v7 offset:1872
    ds_read_b64 v[140:141], v6 offset:2624
    ds_read_b64 v[142:143], v6 offset:2632
    s_waitcnt lgkmcnt(7)
    v_mfma_f32_32x32x16_bf16 v[64:79], v[120:123], v[124:127], v[64:79]
    v_and_b32 v167, 0xffff0000, v39
    ds_read_b64 v[96:97], v6 offset:672
    ds_read_b64 v[98:99], v6 offset:680
    s_waitcnt lgkmcnt(7)
    v_mfma_f32_32x32x16_bf16 v[80:95], v[128:131], v[124:127], v[80:95]
    v_lshlrev_b32_e64 v183, 16, v39
    ds_read_b128 v[100:103], v7 offset:1760
    ds_read_b64 v[104:105], v6 offset:2720
    ds_read_b64 v[106:107], v6 offset:2728
    s_waitcnt lgkmcnt(7)
    v_mfma_f32_32x32x16_bf16 v[64:79], v[132:135], v[136:139], v[64:79]
    v_and_b32 v168, 0xffff0000, v40
    ds_read_b64 v[108:109], v6 offset:640
    ds_read_b64 v[110:111], v6 offset:648
    s_waitcnt lgkmcnt(7)
    v_mfma_f32_32x32x16_bf16 v[80:95], v[140:143], v[136:139], v[80:95]
    v_lshlrev_b32_e64 v184, 16, v40
    ds_read_b128 v[112:115], v7 offset:1792
    ds_read_b64 v[116:117], v6 offset:2688
    ds_read_b64 v[118:119], v6 offset:2696
    s_waitcnt lgkmcnt(7)
    v_mfma_f32_32x32x16_bf16 v[64:79], v[96:99], v[100:103], v[64:79]
    v_and_b32 v169, 0xffff0000, v41
    ds_read_b64 v[120:121], v6 offset:736
    ds_read_b64 v[122:123], v6 offset:744
    s_waitcnt lgkmcnt(7)
    v_mfma_f32_32x32x16_bf16 v[80:95], v[104:107], v[100:103], v[80:95]
    v_lshlrev_b32_e64 v185, 16, v41
    ds_read_b128 v[124:127], v7 offset:1680
    ds_read_b64 v[128:129], v6 offset:2784
    ds_read_b64 v[130:131], v6 offset:2792
    s_waitcnt lgkmcnt(7)
    v_mfma_f32_32x32x16_bf16 v[64:79], v[108:111], v[112:115], v[64:79]
    v_and_b32 v170, 0xffff0000, v42
    ds_read_b64 v[132:133], v6 offset:704
    ds_read_b64 v[134:135], v6 offset:712
    s_waitcnt lgkmcnt(7)
    v_mfma_f32_32x32x16_bf16 v[80:95], v[116:119], v[112:115], v[80:95]
    v_lshlrev_b32_e64 v186, 16, v42
    ds_read_b128 v[136:139], v7 offset:1712
    ds_read_b64 v[140:141], v6 offset:2752
    ds_read_b64 v[142:143], v6 offset:2760
    s_waitcnt lgkmcnt(7)
    v_mfma_f32_32x32x16_bf16 v[64:79], v[120:123], v[124:127], v[64:79]
    v_and_b32 v171, 0xffff0000, v43
    ds_read_b64 v[96:97], v6 offset:800
    ds_read_b64 v[98:99], v6 offset:808
    s_waitcnt lgkmcnt(7)
    v_mfma_f32_32x32x16_bf16 v[80:95], v[128:131], v[124:127], v[80:95]
    v_lshlrev_b32_e64 v187, 16, v43
    ds_read_b128 v[100:103], v7 offset:1600
    ds_read_b64 v[104:105], v6 offset:2848
    ds_read_b64 v[106:107], v6 offset:2856
    s_waitcnt lgkmcnt(7)
    v_mfma_f32_32x32x16_bf16 v[64:79], v[132:135], v[136:139], v[64:79]
    v_and_b32 v172, 0xffff0000, v44
    ds_read_b64 v[108:109], v6 offset:768
    ds_read_b64 v[110:111], v6 offset:776
    s_waitcnt lgkmcnt(7)
    v_mfma_f32_32x32x16_bf16 v[80:95], v[140:143], v[136:139], v[80:95]
    v_lshlrev_b32_e64 v188, 16, v44
    ds_read_b128 v[112:115], v7 offset:1632
    ds_read_b64 v[116:117], v6 offset:2816
    ds_read_b64 v[118:119], v6 offset:2824
    s_waitcnt lgkmcnt(7)
    v_mfma_f32_32x32x16_bf16 v[64:79], v[96:99], v[100:103], v[64:79]
    v_and_b32 v173, 0xffff0000, v45
    ds_read_b64 v[120:121], v6 offset:864
    ds_read_b64 v[122:123], v6 offset:872
    s_waitcnt lgkmcnt(7)
    v_mfma_f32_32x32x16_bf16 v[80:95], v[104:107], v[100:103], v[80:95]
    v_lshlrev_b32_e64 v189, 16, v45
    ds_read_b128 v[124:127], v7 offset:1520
    ds_read_b64 v[128:129], v6 offset:2912
    ds_read_b64 v[130:131], v6 offset:2920
    s_waitcnt lgkmcnt(7)
    v_mfma_f32_32x32x16_bf16 v[64:79], v[108:111], v[112:115], v[64:79]
    v_and_b32 v174, 0xffff0000, v46
    ds_read_b64 v[132:133], v6 offset:832
    ds_read_b64 v[134:135], v6 offset:840
    s_waitcnt lgkmcnt(7)
    v_mfma_f32_32x32x16_bf16 v[80:95], v[116:119], v[112:115], v[80:95]
    v_lshlrev_b32_e64 v190, 16, v46
    ds_read_b128 v[136:139], v7 offset:1552
    ds_read_b64 v[140:141], v6 offset:2880
    ds_read_b64 v[142:143], v6 offset:2888
    s_waitcnt lgkmcnt(7)
    v_mfma_f32_32x32x16_bf16 v[64:79], v[120:123], v[124:127], v[64:79]
    v_and_b32 v175, 0xffff0000, v47
    ds_read_b64 v[96:97], v6 offset:928
    ds_read_b64 v[98:99], v6 offset:936
    s_waitcnt lgkmcnt(7)
    v_mfma_f32_32x32x16_bf16 v[80:95], v[128:131], v[124:127], v[80:95]
    ds_read_b128 v[100:103], v7 offset:1440
    ds_read_b64 v[104:105], v6 offset:2976
    ds_read_b64 v[106:107], v6 offset:2984
    s_waitcnt lgkmcnt(7)
    v_mfma_f32_32x32x16_bf16 v[64:79], v[132:135], v[136:139], v[64:79]
    v_lshlrev_b32 v191, 16, v47
    ds_read_b64 v[108:109], v6 offset:896
    ds_read_b64 v[110:111], v6 offset:904
    s_waitcnt lgkmcnt(7)
    v_mfma_f32_32x32x16_bf16 v[80:95], v[140:143], v[136:139], v[80:95]
    ds_read_b128 v[112:115], v7 offset:1472
    ds_read_b64 v[116:117], v6 offset:2944
    ds_read_b64 v[118:119], v6 offset:2952
    s_waitcnt lgkmcnt(7)
    v_mfma_f32_32x32x16_bf16 v[64:79], v[96:99], v[100:103], v[64:79]
    ds_read_b64 v[120:121], v6 offset:992
    ds_read_b64 v[122:123], v6 offset:1000
    s_waitcnt lgkmcnt(7)
    v_mfma_f32_32x32x16_bf16 v[80:95], v[104:107], v[100:103], v[80:95]
    ds_read_b128 v[124:127], v7 offset:1360
    ds_read_b64 v[128:129], v6 offset:3040
    ds_read_b64 v[130:131], v6 offset:3048
    s_waitcnt lgkmcnt(7)
    v_mfma_f32_32x32x16_bf16 v[64:79], v[108:111], v[112:115], v[64:79]
    ds_read_b64 v[132:133], v6 offset:960
    ds_read_b64 v[134:135], v6 offset:968
    s_waitcnt lgkmcnt(7)
    v_mfma_f32_32x32x16_bf16 v[80:95], v[116:119], v[112:115], v[80:95]
    ds_read_b128 v[136:139], v7 offset:1392
    ds_read_b64 v[140:141], v6 offset:3008
    ds_read_b64 v[142:143], v6 offset:3016
    s_waitcnt lgkmcnt(7)
    v_mfma_f32_32x32x16_bf16 v[64:79], v[120:123], v[124:127], v[64:79]
    s_waitcnt lgkmcnt(5)
    v_mfma_f32_32x32x16_bf16 v[80:95], v[128:131], v[124:127], v[80:95]
    s_waitcnt lgkmcnt(2)
    v_mfma_f32_32x32x16_bf16 v[64:79], v[132:135], v[136:139], v[64:79]
    s_waitcnt lgkmcnt(0)
    v_mfma_f32_32x32x16_bf16 v[80:95], v[140:143], v[136:139], v[80:95]
    s_lshl_b32 s65, s3, 12
    s_add_u32 s65, s65, 49152
    v_add_u32 v8, s65, v2
    s_xor_b32 s66, s3, 1
    s_lshl_b32 s66, s66, 12
    s_add_u32 s66, s66, 49152
    v_add_u32 v9, s66, v2
    s_mul_i32 s65, s64, 384
    v_subrev_u32_e64 v10, s65, v6
    s_mul_i32 s65, s64, 480
    v_add_u32 v11, s65, v7
    s_lshl_b32 s65, s3, 11
    s_add_u32 s65, s65, 65536
    v_and_b32 v12, 31, v1
    v_lshlrev_b32 v12, 6, v12
    v_lshl_add_u32 v12, v3, 3, v12
    v_add_u32 v12, s65, v12
    v_add_u32 v13, s65, v2
    s_lshl_b32 s67, s70, 13
    s_lshl_b32 s66, s3, 11
    s_add_u32 s67, s67, s66
    s_add_u32 s67, s67, 3670016
    s_nop 7
    s_cmp_eq_u32 s64, 0
    s_cbranch_scc1 sequential_preLN__ssm_conv_s4d__glu_gated_swiglu__prompt_kernel_cj118
    ds_write_b128 v8, v[64:67] offset:0
    ds_write_b128 v8, v[68:71] offset:1024
    ds_write_b128 v8, v[72:75] offset:2048
    ds_write_b128 v8, v[76:79] offset:3072
    s_waitcnt lgkmcnt(0)
sequential_preLN__ssm_conv_s4d__glu_gated_swiglu__prompt_kernel_cj118:
    s_waitcnt vmcnt(0)
    s_barrier
    s_cmp_lg_u32 s3, 0
    s_cbranch_scc1 sequential_preLN__ssm_conv_s4d__glu_gated_swiglu__prompt_kernel_fs22
    s_lshl_b32 s52, s2, 7
    s_add_u32 s52, s52, 17842176
    v_lshlrev_b32 v4, 2, v1
    v_mov_b32 v5, s71
    s_mov_b32 exec_hi, 0
    buffer_store_dword v5, v4, s[32:35], s52 offen sc1
    s_mov_b32 exec_hi, -1
sequential_preLN__ssm_conv_s4d__glu_gated_swiglu__prompt_kernel_fs22:
    s_cmp_lg_u32 s64, 0
    s_cbranch_scc1 sequential_preLN__ssm_conv_s4d__glu_gated_swiglu__prompt_kernel_cp1b19
    ds_read_b128 v[144:147], v9 offset:0
    ds_read_b128 v[148:151], v9 offset:1024
    ds_read_b128 v[152:155], v9 offset:2048
    ds_read_b128 v[156:159], v9 offset:3072
    s_waitcnt lgkmcnt(3)
    v_pk_add_f32 v[64:65], v[64:65], v[144:145]
    v_cvt_pk_bf16_f32 v232, v64, v65
    v_lshlrev_b32 v234, 16, v232
    v_and_b32_e64 v235, s68, v232
    v_pk_add_f32 v[234:235], v[234:235], v[160:161]
    v_cvt_pk_bf16_f32 v232, v234, v235
    v_lshlrev_b32 v234, 16, v232
    v_and_b32 v235, s68, v232
    v_pk_add_f32 v[234:235], v[234:235], v[176:177]
    v_cvt_pk_bf16_f32 v192, v234, v235
    v_pk_add_f32 v[66:67], v[66:67], v[146:147]
    v_cvt_pk_bf16_f32 v236, v66, v67
    v_lshlrev_b32 v238, 16, v236
    v_and_b32 v239, s68, v236
    v_pk_add_f32 v[238:239], v[238:239], v[162:163]
    v_cvt_pk_bf16_f32 v236, v238, v239
    v_lshlrev_b32 v238, 16, v236
    v_and_b32 v239, s68, v236
    v_pk_add_f32 v[238:239], v[238:239], v[178:179]
    v_cvt_pk_bf16_f32 v193, v238, v239
    s_waitcnt lgkmcnt(2)
    v_pk_add_f32 v[68:69], v[68:69], v[148:149]
    v_cvt_pk_bf16_f32 v232, v68, v69
    v_lshlrev_b32 v234, 16, v232
    v_and_b32_e64 v235, s68, v232
    v_pk_add_f32 v[234:235], v[234:235], v[164:165]
    v_cvt_pk_bf16_f32 v232, v234, v235
    v_lshlrev_b32 v234, 16, v232
    v_and_b32 v235, s68, v232
    v_pk_add_f32 v[234:235], v[234:235], v[180:181]
    v_cvt_pk_bf16_f32 v194, v234, v235
    v_pk_add_f32 v[70:71], v[70:71], v[150:151]
    v_cvt_pk_bf16_f32 v236, v70, v71
    v_lshlrev_b32 v238, 16, v236
    v_and_b32 v239, s68, v236
    v_pk_add_f32 v[238:239], v[238:239], v[166:167]
    v_cvt_pk_bf16_f32 v236, v238, v239
    v_lshlrev_b32 v238, 16, v236
    v_and_b32 v239, s68, v236
    v_pk_add_f32 v[238:239], v[238:239], v[182:183]
    v_cvt_pk_bf16_f32 v195, v238, v239
    s_waitcnt lgkmcnt(1)
    v_pk_add_f32 v[72:73], v[72:73], v[152:153]
    v_cvt_pk_bf16_f32 v232, v72, v73
    v_lshlrev_b32 v234, 16, v232
    v_and_b32_e64 v235, s68, v232
    v_pk_add_f32 v[234:235], v[234:235], v[168:169]
    v_cvt_pk_bf16_f32 v232, v234, v235
    v_lshlrev_b32 v234, 16, v232
    v_and_b32 v235, s68, v232
    v_pk_add_f32 v[234:235], v[234:235], v[184:185]
    v_cvt_pk_bf16_f32 v196, v234, v235
    v_pk_add_f32 v[74:75], v[74:75], v[154:155]
    v_cvt_pk_bf16_f32 v236, v74, v75
    v_lshlrev_b32 v238, 16, v236
    v_and_b32 v239, s68, v236
    v_pk_add_f32 v[238:239], v[238:239], v[170:171]
    v_cvt_pk_bf16_f32 v236, v238, v239
    v_lshlrev_b32 v238, 16, v236
    v_and_b32 v239, s68, v236
    v_pk_add_f32 v[238:239], v[238:239], v[186:187]
    v_cvt_pk_bf16_f32 v197, v238, v239
    s_waitcnt lgkmcnt(0)
    v_pk_add_f32 v[76:77], v[76:77], v[156:157]
    v_cvt_pk_bf16_f32 v232, v76, v77
    v_lshlrev_b32 v234, 16, v232
    v_and_b32_e64 v235, s68, v232
    v_pk_add_f32 v[234:235], v[234:235], v[172:173]
    v_cvt_pk_bf16_f32 v232, v234, v235
    v_lshlrev_b32 v234, 16, v232
    v_and_b32 v235, s68, v232
    v_pk_add_f32 v[234:235], v[234:235], v[188:189]
    v_cvt_pk_bf16_f32 v198, v234, v235
    v_pk_add_f32 v[78:79], v[78:79], v[158:159]
    v_cvt_pk_bf16_f32 v236, v78, v79
    v_lshlrev_b32 v238, 16, v236
    v_and_b32 v239, s68, v236
    v_pk_add_f32 v[238:239], v[238:239], v[174:175]
    v_cvt_pk_bf16_f32 v236, v238, v239
    v_lshlrev_b32 v238, 16, v236
    v_and_b32 v239, s68, v236
    v_pk_add_f32 v[238:239], v[238:239], v[190:191]
    v_cvt_pk_bf16_f32 v199, v238, v239
    ds_write_b64 v12, v[192:193] offset:0
    ds_write_b64 v12, v[194:195] offset:16
    ds_write_b64 v12, v[196:197] offset:32
    ds_write_b64 v12, v[198:199] offset:48
    ds_read_b128 v[200:203], v13 offset:0
    ds_read_b128 v[204:207], v13 offset:1024
    s_waitcnt lgkmcnt(1)
    buffer_store_dwordx4 v[200:203], v2, s[32:35], s67 offen offset:0 sc1
    s_waitcnt lgkmcnt(0)
    buffer_store_dwordx4 v[204:207], v2, s[32:35], s67 offen offset:1024 sc1
    ds_read_b64 v[96:97], v10 offset:32
    ds_read_b64 v[98:99], v10 offset:40
    ds_read_b128 v[100:103], v11 offset:5120
    ds_read_b64 v[104:105], v10 offset:0
    ds_read_b64 v[106:107], v10 offset:8
    ds_read_b128 v[108:111], v11 offset:5152
    ds_read_b64 v[112:113], v10 offset:96
    ds_read_b64 v[114:115], v10 offset:104
    ds_read_b128 v[116:119], v11 offset:5040
    ds_read_b64 v[120:121], v10 offset:64
    ds_read_b64 v[122:123], v10 offset:72
    ds_read_b128 v[124:127], v11 offset:5072
    s_waitcnt lgkmcnt(9)
    v_mfma_f32_32x32x16_bf16 v[80:95], v[96:99], v[100:103], v[80:95]
    ds_read_b64 v[128:129], v10 offset:160
    ds_read_b64 v[130:131], v10 offset:168
    ds_read_b128 v[132:135], v11 offset:4960
    s_waitcnt lgkmcnt(9)
    v_mfma_f32_32x32x16_bf16 v[80:95], v[104:107], v[108:111], v[80:95]
    ds_read_b64 v[136:137], v10 offset:128
    ds_read_b64 v[138:139], v10 offset:136
    ds_read_b128 v[140:143], v11 offset:4992
    s_waitcnt lgkmcnt(9)
    v_mfma_f32_32x32x16_bf16 v[80:95], v[112:115], v[116:119], v[80:95]
    ds_read_b64 v[96:97], v10 offset:224
    ds_read_b64 v[98:99], v10 offset:232
    ds_read_b128 v[100:103], v11 offset:4880
    s_waitcnt lgkmcnt(9)
    v_mfma_f32_32x32x16_bf16 v[80:95], v[120:123], v[124:127], v[80:95]
    ds_read_b64 v[104:105], v10 offset:192
    ds_read_b64 v[106:107], v10 offset:200
    ds_read_b128 v[108:111], v11 offset:4912
    s_waitcnt lgkmcnt(9)
    v_mfma_f32_32x32x16_bf16 v[80:95], v[128:131], v[132:135], v[80:95]
    ds_read_b64 v[112:113], v10 offset:288
    ds_read_b64 v[114:115], v10 offset:296
    ds_read_b128 v[116:119], v11 offset:4800
    s_waitcnt lgkmcnt(9)
    v_mfma_f32_32x32x16_bf16 v[80:95], v[136:139], v[140:143], v[80:95]
    ds_read_b64 v[120:121], v10 offset:256
    ds_read_b64 v[122:123], v10 offset:264
    ds_read_b128 v[124:127], v11 offset:4832
    s_waitcnt lgkmcnt(9)
    v_mfma_f32_32x32x16_bf16 v[80:95], v[96:99], v[100:103], v[80:95]
    ds_read_b64 v[128:129], v10 offset:352
    ds_read_b64 v[130:131], v10 offset:360
    ds_read_b128 v[132:135], v11 offset:4720
    s_waitcnt lgkmcnt(9)
    v_mfma_f32_32x32x16_bf16 v[80:95], v[104:107], v[108:111], v[80:95]
    ds_read_b64 v[136:137], v10 offset:320
    ds_read_b64 v[138:139], v10 offset:328
    ds_read_b128 v[140:143], v11 offset:4752
    s_waitcnt lgkmcnt(9)
    v_mfma_f32_32x32x16_bf16 v[80:95], v[112:115], v[116:119], v[80:95]
    ds_read_b64 v[96:97], v10 offset:416
    ds_read_b64 v[98:99], v10 offset:424
    ds_read_b128 v[100:103], v11 offset:4640
    s_waitcnt lgkmcnt(9)
    v_mfma_f32_32x32x16_bf16 v[80:95], v[120:123], v[124:127], v[80:95]
    ds_read_b64 v[104:105], v10 offset:384
    ds_read_b64 v[106:107], v10 offset:392
    ds_read_b128 v[108:111], v11 offset:4672
    s_waitcnt lgkmcnt(9)
    v_mfma_f32_32x32x16_bf16 v[80:95], v[128:131], v[132:135], v[80:95]
    ds_read_b64 v[112:113], v10 offset:480
    ds_read_b64 v[114:115], v10 offset:488
    ds_read_b128 v[116:119], v11 offset:4560
    s_waitcnt lgkmcnt(9)
    v_mfma_f32_32x32x16_bf16 v[80:95], v[136:139], v[140:143], v[80:95]
    ds_read_b64 v[120:121], v10 offset:448
    ds_read_b64 v[122:123], v10 offset:456
    ds_read_b128 v[124:127], v11 offset:4592
    s_waitcnt lgkmcnt(9)
    v_mfma_f32_32x32x16_bf16 v[80:95], v[96:99], v[100:103], v[80:95]
    ds_read_b64 v[128:129], v10 offset:544
    ds_read_b64 v[130:131], v10 offset:552
    ds_read_b128 v[132:135], v11 offset:4480
    s_waitcnt lgkmcnt(9)
    v_mfma_f32_32x32x16_bf16 v[80:95], v[104:107], v[108:111], v[80:95]
    ds_read_b64 v[136:137], v10 offset:512
    ds_read_b64 v[138:139], v10 offset:520
    ds_read_b128 v[140:143], v11 offset:4512
    s_waitcnt lgkmcnt(9)
    v_mfma_f32_32x32x16_bf16 v[80:95], v[112:115], v[116:119], v[80:95]
    ds_read_b64 v[96:97], v10 offset:608
    ds_read_b64 v[98:99], v10 offset:616
    ds_read_b128 v[100:103], v11 offset:4400
    s_waitcnt lgkmcnt(9)
    v_mfma_f32_32x32x16_bf16 v[80:95], v[120:123], v[124:127], v[80:95]
    ds_read_b64 v[104:105], v10 offset:576
    ds_read_b64 v[106:107], v10 offset:584
    ds_read_b128 v[108:111], v11 offset:4432
    s_waitcnt lgkmcnt(9)
    v_mfma_f32_32x32x16_bf16 v[80:95], v[128:131], v[132:135], v[80:95]
    s_waitcnt lgkmcnt(6)
    v_mfma_f32_32x32x16_bf16 v[80:95], v[136:139], v[140:143], v[80:95]
    s_waitcnt lgkmcnt(3)
    v_mfma_f32_32x32x16_bf16 v[80:95], v[96:99], v[100:103], v[80:95]
    s_waitcnt lgkmcnt(0)
    v_mfma_f32_32x32x16_bf16 v[80:95], v[104:107], v[108:111], v[80:95]
    s_nop 11
    ds_write_b128 v8, v[80:83] offset:0
    ds_write_b128 v8, v[84:87] offset:1024
    ds_write_b128 v8, v[88:91] offset:2048
    ds_write_b128 v8, v[92:95] offset:3072
    s_waitcnt lgkmcnt(0)
    s_waitcnt vmcnt(0)
    s_branch sequential_preLN__ssm_conv_s4d__glu_gated_swiglu__prompt_kernel_cj220
sequential_preLN__ssm_conv_s4d__glu_gated_swiglu__prompt_kernel_cp1b19:
    ds_read_b64 v[96:97], v10 offset:32
    ds_read_b64 v[98:99], v10 offset:40
    ds_read_b128 v[100:103], v11 offset:5120
    ds_read_b64 v[104:105], v10 offset:0
    ds_read_b64 v[106:107], v10 offset:8
    ds_read_b128 v[108:111], v11 offset:5152
    ds_read_b64 v[112:113], v10 offset:96
    ds_read_b64 v[114:115], v10 offset:104
    ds_read_b128 v[116:119], v11 offset:5040
    ds_read_b64 v[120:121], v10 offset:64
    ds_read_b64 v[122:123], v10 offset:72
    ds_read_b128 v[124:127], v11 offset:5072
    s_waitcnt lgkmcnt(9)
    v_mfma_f32_32x32x16_bf16 v[80:95], v[96:99], v[100:103], v[80:95]
    ds_read_b64 v[128:129], v10 offset:160
    ds_read_b64 v[130:131], v10 offset:168
    ds_read_b128 v[132:135], v11 offset:4960
    s_waitcnt lgkmcnt(9)
    v_mfma_f32_32x32x16_bf16 v[80:95], v[104:107], v[108:111], v[80:95]
    ds_read_b64 v[136:137], v10 offset:128
    ds_read_b64 v[138:139], v10 offset:136
    ds_read_b128 v[140:143], v11 offset:4992
    s_waitcnt lgkmcnt(9)
    v_mfma_f32_32x32x16_bf16 v[80:95], v[112:115], v[116:119], v[80:95]
    ds_read_b64 v[96:97], v10 offset:224
    ds_read_b64 v[98:99], v10 offset:232
    ds_read_b128 v[100:103], v11 offset:4880
    s_waitcnt lgkmcnt(9)
    v_mfma_f32_32x32x16_bf16 v[80:95], v[120:123], v[124:127], v[80:95]
    ds_read_b64 v[104:105], v10 offset:192
    ds_read_b64 v[106:107], v10 offset:200
    ds_read_b128 v[108:111], v11 offset:4912
    s_waitcnt lgkmcnt(9)
    v_mfma_f32_32x32x16_bf16 v[80:95], v[128:131], v[132:135], v[80:95]
    ds_read_b64 v[112:113], v10 offset:288
    ds_read_b64 v[114:115], v10 offset:296
    ds_read_b128 v[116:119], v11 offset:4800
    s_waitcnt lgkmcnt(9)
    v_mfma_f32_32x32x16_bf16 v[80:95], v[136:139], v[140:143], v[80:95]
    ds_read_b64 v[120:121], v10 offset:256
    ds_read_b64 v[122:123], v10 offset:264
    ds_read_b128 v[124:127], v11 offset:4832
    s_waitcnt lgkmcnt(9)
    v_mfma_f32_32x32x16_bf16 v[80:95], v[96:99], v[100:103], v[80:95]
    ds_read_b64 v[128:129], v10 offset:352
    ds_read_b64 v[130:131], v10 offset:360
    ds_read_b128 v[132:135], v11 offset:4720
    s_waitcnt lgkmcnt(9)
    v_mfma_f32_32x32x16_bf16 v[80:95], v[104:107], v[108:111], v[80:95]
    ds_read_b64 v[136:137], v10 offset:320
    ds_read_b64 v[138:139], v10 offset:328
    ds_read_b128 v[140:143], v11 offset:4752
    s_waitcnt lgkmcnt(9)
    v_mfma_f32_32x32x16_bf16 v[80:95], v[112:115], v[116:119], v[80:95]
    ds_read_b64 v[96:97], v10 offset:416
    ds_read_b64 v[98:99], v10 offset:424
    ds_read_b128 v[100:103], v11 offset:4640
    s_waitcnt lgkmcnt(9)
    v_mfma_f32_32x32x16_bf16 v[80:95], v[120:123], v[124:127], v[80:95]
    ds_read_b64 v[104:105], v10 offset:384
    ds_read_b64 v[106:107], v10 offset:392
    ds_read_b128 v[108:111], v11 offset:4672
    s_waitcnt lgkmcnt(9)
    v_mfma_f32_32x32x16_bf16 v[80:95], v[128:131], v[132:135], v[80:95]
    ds_read_b64 v[112:113], v10 offset:480
    ds_read_b64 v[114:115], v10 offset:488
    ds_read_b128 v[116:119], v11 offset:4560
    s_waitcnt lgkmcnt(9)
    v_mfma_f32_32x32x16_bf16 v[80:95], v[136:139], v[140:143], v[80:95]
    ds_read_b64 v[120:121], v10 offset:448
    ds_read_b64 v[122:123], v10 offset:456
    ds_read_b128 v[124:127], v11 offset:4592
    s_waitcnt lgkmcnt(9)
    v_mfma_f32_32x32x16_bf16 v[80:95], v[96:99], v[100:103], v[80:95]
    ds_read_b64 v[128:129], v10 offset:544
    ds_read_b64 v[130:131], v10 offset:552
    ds_read_b128 v[132:135], v11 offset:4480
    s_waitcnt lgkmcnt(9)
    v_mfma_f32_32x32x16_bf16 v[80:95], v[104:107], v[108:111], v[80:95]
    ds_read_b64 v[136:137], v10 offset:512
    ds_read_b64 v[138:139], v10 offset:520
    ds_read_b128 v[140:143], v11 offset:4512
    s_waitcnt lgkmcnt(9)
    v_mfma_f32_32x32x16_bf16 v[80:95], v[112:115], v[116:119], v[80:95]
    ds_read_b64 v[96:97], v10 offset:608
    ds_read_b64 v[98:99], v10 offset:616
    ds_read_b128 v[100:103], v11 offset:4400
    s_waitcnt lgkmcnt(9)
    v_mfma_f32_32x32x16_bf16 v[80:95], v[120:123], v[124:127], v[80:95]
    ds_read_b64 v[104:105], v10 offset:576
    ds_read_b64 v[106:107], v10 offset:584
    ds_read_b128 v[108:111], v11 offset:4432
    s_waitcnt lgkmcnt(9)
    v_mfma_f32_32x32x16_bf16 v[80:95], v[128:131], v[132:135], v[80:95]
    ds_read_b64 v[112:113], v10 offset:672
    ds_read_b64 v[114:115], v10 offset:680
    ds_read_b128 v[116:119], v11 offset:4320
    s_waitcnt lgkmcnt(9)
    v_mfma_f32_32x32x16_bf16 v[80:95], v[136:139], v[140:143], v[80:95]
    ds_read_b64 v[120:121], v10 offset:640
    ds_read_b64 v[122:123], v10 offset:648
    ds_read_b128 v[124:127], v11 offset:4352
    s_waitcnt lgkmcnt(9)
    v_mfma_f32_32x32x16_bf16 v[80:95], v[96:99], v[100:103], v[80:95]
    ds_read_b64 v[128:129], v10 offset:736
    ds_read_b64 v[130:131], v10 offset:744
    ds_read_b128 v[132:135], v11 offset:4240
    s_waitcnt lgkmcnt(9)
    v_mfma_f32_32x32x16_bf16 v[80:95], v[104:107], v[108:111], v[80:95]
    ds_read_b64 v[136:137], v10 offset:704
    ds_read_b64 v[138:139], v10 offset:712
    ds_read_b128 v[140:143], v11 offset:4272
    s_waitcnt lgkmcnt(9)
    v_mfma_f32_32x32x16_bf16 v[80:95], v[112:115], v[116:119], v[80:95]
    ds_read_b64 v[96:97], v10 offset:800
    ds_read_b64 v[98:99], v10 offset:808
    ds_read_b128 v[100:103], v11 offset:4160
    s_waitcnt lgkmcnt(9)
    v_mfma_f32_32x32x16_bf16 v[80:95], v[120:123], v[124:127], v[80:95]
    ds_read_b64 v[104:105], v10 offset:768
    ds_read_b64 v[106:107], v10 offset:776
    ds_read_b128 v[108:111], v11 offset:4192
    s_waitcnt lgkmcnt(9)
    v_mfma_f32_32x32x16_bf16 v[80:95], v[128:131], v[132:135], v[80:95]
    ds_read_b64 v[112:113], v10 offset:864
    ds_read_b64 v[114:115], v10 offset:872
    ds_read_b128 v[116:119], v11 offset:4080
    s_waitcnt lgkmcnt(9)
    v_mfma_f32_32x32x16_bf16 v[80:95], v[136:139], v[140:143], v[80:95]
    ds_read_b64 v[120:121], v10 offset:832
    ds_read_b64 v[122:123], v10 offset:840
    ds_read_b128 v[124:127], v11 offset:4112
    s_waitcnt lgkmcnt(9)
    v_mfma_f32_32x32x16_bf16 v[80:95], v[96:99], v[100:103], v[80:95]
    ds_read_b64 v[128:129], v10 offset:928
    ds_read_b64 v[130:131], v10 offset:936
    ds_read_b128 v[132:135], v11 offset:4000
    s_waitcnt lgkmcnt(9)
    v_mfma_f32_32x32x16_bf16 v[80:95], v[104:107], v[108:111], v[80:95]
    ds_read_b64 v[136:137], v10 offset:896
    ds_read_b64 v[138:139], v10 offset:904
    ds_read_b128 v[140:143], v11 offset:4032
    s_waitcnt lgkmcnt(9)
    v_mfma_f32_32x32x16_bf16 v[80:95], v[112:115], v[116:119], v[80:95]
    ds_read_b64 v[96:97], v10 offset:992
    ds_read_b64 v[98:99], v10 offset:1000
    ds_read_b128 v[100:103], v11 offset:3920
    s_waitcnt lgkmcnt(9)
    v_mfma_f32_32x32x16_bf16 v[80:95], v[120:123], v[124:127], v[80:95]
    ds_read_b64 v[104:105], v10 offset:960
    ds_read_b64 v[106:107], v10 offset:968
    ds_read_b128 v[108:111], v11 offset:3952
    s_waitcnt lgkmcnt(9)
    v_mfma_f32_32x32x16_bf16 v[80:95], v[128:131], v[132:135], v[80:95]
    ds_read_b64 v[112:113], v10 offset:1056
    ds_read_b64 v[114:115], v10 offset:1064
    ds_read_b128 v[116:119], v11 offset:3840
    s_waitcnt lgkmcnt(9)
    v_mfma_f32_32x32x16_bf16 v[80:95], v[136:139], v[140:143], v[80:95]
    ds_read_b64 v[120:121], v10 offset:1024
    ds_read_b64 v[122:123], v10 offset:1032
    ds_read_b128 v[124:127], v11 offset:3872
    s_waitcnt lgkmcnt(9)
    v_mfma_f32_32x32x16_bf16 v[80:95], v[96:99], v[100:103], v[80:95]
    ds_read_b64 v[128:129], v10 offset:1120
    ds_read_b64 v[130:131], v10 offset:1128
    ds_read_b128 v[132:135], v11 offset:3760
    s_waitcnt lgkmcnt(9)
    v_mfma_f32_32x32x16_bf16 v[80:95], v[104:107], v[108:111], v[80:95]
    ds_read_b64 v[136:137], v10 offset:1088
    ds_read_b64 v[138:139], v10 offset:1096
    ds_read_b128 v[140:143], v11 offset:3792
    s_waitcnt lgkmcnt(9)
    v_mfma_f32_32x32x16_bf16 v[80:95], v[112:115], v[116:119], v[80:95]
    ds_read_b64 v[96:97], v10 offset:1184
    ds_read_b64 v[98:99], v10 offset:1192
    ds_read_b128 v[100:103], v11 offset:3680
    s_waitcnt lgkmcnt(9)
    v_mfma_f32_32x32x16_bf16 v[80:95], v[120:123], v[124:127], v[80:95]
    ds_read_b64 v[104:105], v10 offset:1152
    ds_read_b64 v[106:107], v10 offset:1160
    ds_read_b128 v[108:111], v11 offset:3712
    s_waitcnt lgkmcnt(9)
    v_mfma_f32_32x32x16_bf16 v[80:95], v[128:131], v[132:135], v[80:95]
    ds_read_b64 v[112:113], v10 offset:1248
    ds_read_b64 v[114:115], v10 offset:1256
    ds_read_b128 v[116:119], v11 offset:3600
    s_waitcnt lgkmcnt(9)
    v_mfma_f32_32x32x16_bf16 v[80:95], v[136:139], v[140:143], v[80:95]
    ds_read_b64 v[120:121], v10 offset:1216
    ds_read_b64 v[122:123], v10 offset:1224
    ds_read_b128 v[124:127], v11 offset:3632
    s_waitcnt lgkmcnt(9)
    v_mfma_f32_32x32x16_bf16 v[80:95], v[96:99], v[100:103], v[80:95]
    ds_read_b64 v[128:129], v10 offset:1312
    ds_read_b64 v[130:131], v10 offset:1320
    ds_read_b128 v[132:135], v11 offset:3520
    s_waitcnt lgkmcnt(9)
    v_mfma_f32_32x32x16_bf16 v[80:95], v[104:107], v[108:111], v[80:95]
    ds_read_b64 v[136:137], v10 offset:1280
    ds_read_b64 v[138:139], v10 offset:1288
    ds_read_b128 v[140:143], v11 offset:3552
    s_waitcnt lgkmcnt(9)
    v_mfma_f32_32x32x16_bf16 v[80:95], v[112:115], v[116:119], v[80:95]
    ds_read_b64 v[96:97], v10 offset:1376
    ds_read_b64 v[98:99], v10 offset:1384
    ds_read_b128 v[100:103], v11 offset:3440
    s_waitcnt lgkmcnt(9)
    v_mfma_f32_32x32x16_bf16 v[80:95], v[120:123], v[124:127], v[80:95]
    ds_read_b64 v[104:105], v10 offset:1344
    ds_read_b64 v[106:107], v10 offset:1352
    ds_read_b128 v[108:111], v11 offset:3472
    s_waitcnt lgkmcnt(9)
    v_mfma_f32_32x32x16_bf16 v[80:95], v[128:131], v[132:135], v[80:95]
    s_waitcnt lgkmcnt(6)
    v_mfma_f32_32x32x16_bf16 v[80:95], v[136:139], v[140:143], v[80:95]
    s_waitcnt lgkmcnt(3)
    v_mfma_f32_32x32x16_bf16 v[80:95], v[96:99], v[100:103], v[80:95]
    s_waitcnt lgkmcnt(0)
    v_mfma_f32_32x32x16_bf16 v[80:95], v[104:107], v[108:111], v[80:95]
sequential_preLN__ssm_conv_s4d__glu_gated_swiglu__prompt_kernel_cj220:
    s_barrier
    s_and_b32 s52, s2, 31
    s_lshl_b32 s52, s52, 7
    s_add_u32 s52, s52, 17661952
    s_cmp_lg_u32 s3, 0
    s_cbranch_scc1 sequential_preLN__ssm_conv_s4d__glu_gated_swiglu__prompt_kernel_arr23
    v_mov_b32 v4, s52
    v_mov_b32 v5, 1
    s_mov_b64 exec, 1
    global_atomic_add v4, v5, s[30:31]
    s_mov_b64 exec, -1
sequential_preLN__ssm_conv_s4d__glu_gated_swiglu__prompt_kernel_arr23:
    v_lshlrev_b32 v4, 7, v1
    s_mov_b32 s53, 17842176
    buffer_load_dword v20, v4, s[32:35], s53 offen sc1
    s_mov_b32 s53, 17850368
    buffer_load_dword v21, v4, s[32:35], s53 offen sc1
    s_mov_b32 s53, 17858560
    buffer_load_dword v22, v4, s[32:35], s53 offen sc1
    s_mov_b32 s53, 17866752
    buffer_load_dword v23, v4, s[32:35], s53 offen sc1
    s_cmp_eq_u32 s64, 0
    s_cbranch_scc1 sequential_preLN__ssm_conv_s4d__glu_gated_swiglu__prompt_kernel_cp0c21
    ds_read_b128 v[144:147], v9 offset:0
    ds_read_b128 v[148:151], v9 offset:1024
    ds_read_b128 v[152:155], v9 offset:2048
    ds_read_b128 v[156:159], v9 offset:3072
    s_waitcnt lgkmcnt(3)
    v_pk_add_f32 v[80:81], v[80:81], v[144:145]
    v_cvt_pk_bf16_f32 v232, v80, v81
    v_lshlrev_b32 v234, 16, v232
    v_and_b32_e64 v235, s68, v232
    v_pk_add_f32 v[234:235], v[234:235], v[160:161]
    v_cvt_pk_bf16_f32 v232, v234, v235
    v_lshlrev_b32 v234, 16, v232
    v_and_b32 v235, s68, v232
    v_pk_add_f32 v[234:235], v[234:235], v[176:177]
    v_cvt_pk_bf16_f32 v192, v234, v235
    v_pk_add_f32 v[82:83], v[82:83], v[146:147]
    v_cvt_pk_bf16_f32 v236, v82, v83
    v_lshlrev_b32 v238, 16, v236
    v_and_b32 v239, s68, v236
    v_pk_add_f32 v[238:239], v[238:239], v[162:163]
    v_cvt_pk_bf16_f32 v236, v238, v239
    v_lshlrev_b32 v238, 16, v236
    v_and_b32 v239, s68, v236
    v_pk_add_f32 v[238:239], v[238:239], v[178:179]
    v_cvt_pk_bf16_f32 v193, v238, v239
    s_waitcnt lgkmcnt(2)
    v_pk_add_f32 v[84:85], v[84:85], v[148:149]
    v_cvt_pk_bf16_f32 v232, v84, v85
    v_lshlrev_b32 v234, 16, v232
    v_and_b32_e64 v235, s68, v232
    v_pk_add_f32 v[234:235], v[234:235], v[164:165]
    v_cvt_pk_bf16_f32 v232, v234, v235
    v_lshlrev_b32 v234, 16, v232
    v_and_b32 v235, s68, v232
    v_pk_add_f32 v[234:235], v[234:235], v[180:181]
    v_cvt_pk_bf16_f32 v194, v234, v235
    v_pk_add_f32 v[86:87], v[86:87], v[150:151]
    v_cvt_pk_bf16_f32 v236, v86, v87
    v_lshlrev_b32 v238, 16, v236
    v_and_b32 v239, s68, v236
    v_pk_add_f32 v[238:239], v[238:239], v[166:167]
    v_cvt_pk_bf16_f32 v236, v238, v239
    v_lshlrev_b32 v238, 16, v236
    v_and_b32 v239, s68, v236
    v_pk_add_f32 v[238:239], v[238:239], v[182:183]
    v_cvt_pk_bf16_f32 v195, v238, v239
    s_waitcnt lgkmcnt(1)
    v_pk_add_f32 v[88:89], v[88:89], v[152:153]
    v_cvt_pk_bf16_f32 v232, v88, v89
    v_lshlrev_b32 v234, 16, v232
    v_and_b32_e64 v235, s68, v232
    v_pk_add_f32 v[234:235], v[234:235], v[168:169]
    v_cvt_pk_bf16_f32 v232, v234, v235
    v_lshlrev_b32 v234, 16, v232
    v_and_b32 v235, s68, v232
    v_pk_add_f32 v[234:235], v[234:235], v[184:185]
    v_cvt_pk_bf16_f32 v196, v234, v235
    v_pk_add_f32 v[90:91], v[90:91], v[154:155]
    v_cvt_pk_bf16_f32 v236, v90, v91
    v_lshlrev_b32 v238, 16, v236
    v_and_b32 v239, s68, v236
    v_pk_add_f32 v[238:239], v[238:239], v[170:171]
    v_cvt_pk_bf16_f32 v236, v238, v239
    v_lshlrev_b32 v238, 16, v236
    v_and_b32 v239, s68, v236
    v_pk_add_f32 v[238:239], v[238:239], v[186:187]
    v_cvt_pk_bf16_f32 v197, v238, v239
    s_waitcnt lgkmcnt(0)
    v_pk_add_f32 v[92:93], v[92:93], v[156:157]
    v_cvt_pk_bf16_f32 v232, v92, v93
    v_lshlrev_b32 v234, 16, v232
    v_and_b32_e64 v235, s68, v232
    v_pk_add_f32 v[234:235], v[234:235], v[172:173]
    v_cvt_pk_bf16_f32 v232, v234, v235
    v_lshlrev_b32 v234, 16, v232
    v_and_b32 v235, s68, v232
    v_pk_add_f32 v[234:235], v[234:235], v[188:189]
    v_cvt_pk_bf16_f32 v198, v234, v235
    v_pk_add_f32 v[94:95], v[94:95], v[158:159]
    v_cvt_pk_bf16_f32 v236, v94, v95
    v_lshlrev_b32 v238, 16, v236
    v_and_b32 v239, s68, v236
    v_pk_add_f32 v[238:239], v[238:239], v[174:175]
    v_cvt_pk_bf16_f32 v236, v238, v239
    v_lshlrev_b32 v238, 16, v236
    v_and_b32 v239, s68, v236
    v_pk_add_f32 v[238:239], v[238:239], v[190:191]
    v_cvt_pk_bf16_f32 v199, v238, v239
    ds_write_b64 v12, v[192:193] offset:0
    ds_write_b64 v12, v[194:195] offset:16
    ds_write_b64 v12, v[196:197] offset:32
    ds_write_b64 v12, v[198:199] offset:48
    ds_read_b128 v[200:203], v13 offset:0
    ds_read_b128 v[204:207], v13 offset:1024
    s_waitcnt lgkmcnt(0)
    s_mov_b32 s52, 0
    s_waitcnt vmcnt(0)
    v_mov_b32 v4, v23
sequential_preLN__ssm_conv_s4d__glu_gated_swiglu__prompt_kernel_wlp226:
    v_xor_b32 v5, s71, v20
    v_xor_b32 v4, s71, v21
    v_or_b32 v5, v5, v4
    v_xor_b32 v4, s71, v22
    v_or_b32 v5, v5, v4
    v_xor_b32 v4, s71, v23
    v_or_b32 v5, v5, v4
    v_cmp_ne_u32 vcc, 0, v5
    s_add_u32 s52, s52, 1
    s_nop 2
    s_cmp_eq_u64 vcc, 0
    s_cbranch_scc1 sequential_preLN__ssm_conv_s4d__glu_gated_swiglu__prompt_kernel_wok25
    s_cmp_ge_u32 s52, 400000
    s_cbranch_scc1 sequential_preLN__ssm_conv_s4d__glu_gated_swiglu__prompt_kernel_wok25
    v_lshlrev_b32 v4, 7, v1
    s_mov_b32 s53, 17842176
    buffer_load_dword v20, v4, s[32:35], s53 offen sc1
    s_mov_b32 s53, 17850368
    buffer_load_dword v21, v4, s[32:35], s53 offen sc1
    s_mov_b32 s53, 17858560
    buffer_load_dword v22, v4, s[32:35], s53 offen sc1
    s_mov_b32 s53, 17866752
    buffer_load_dword v23, v4, s[32:35], s53 offen sc1
    s_waitcnt vmcnt(0) lgkmcnt(0)
    s_branch sequential_preLN__ssm_conv_s4d__glu_gated_swiglu__prompt_kernel_wlp226
sequential_preLN__ssm_conv_s4d__glu_gated_swiglu__prompt_kernel_wok25:
    buffer_store_dwordx4 v[200:203], v2, s[32:35], s67 offen offset:0 sc1
    buffer_store_dwordx4 v[204:207], v2, s[32:35], s67 offen offset:1024 sc1
    s_branch sequential_preLN__ssm_conv_s4d__glu_gated_swiglu__prompt_kernel_cjz24
sequential_preLN__ssm_conv_s4d__glu_gated_swiglu__prompt_kernel_cp0c21:
    s_mov_b32 s52, 0
    s_waitcnt vmcnt(0)
    v_mov_b32 v4, v23
sequential_preLN__ssm_conv_s4d__glu_gated_swiglu__prompt_kernel_wlp228:
    v_xor_b32 v5, s71, v20
    v_xor_b32 v4, s71, v21
    v_or_b32 v5, v5, v4
    v_xor_b32 v4, s71, v22
    v_or_b32 v5, v5, v4
    v_xor_b32 v4, s71, v23
    v_or_b32 v5, v5, v4
    v_cmp_ne_u32 vcc, 0, v5
    s_add_u32 s52, s52, 1
    s_nop 2
    s_cmp_eq_u64 vcc, 0
    s_cbranch_scc1 sequential_preLN__ssm_conv_s4d__glu_gated_swiglu__prompt_kernel_wok27
    s_cmp_ge_u32 s52, 400000
    s_cbranch_scc1 sequential_preLN__ssm_conv_s4d__glu_gated_swiglu__prompt_kernel_wok27
    v_lshlrev_b32 v4, 7, v1
    s_mov_b32 s53, 17842176
    buffer_load_dword v20, v4, s[32:35], s53 offen sc1
    s_mov_b32 s53, 17850368
    buffer_load_dword v21, v4, s[32:35], s53 offen sc1
    s_mov_b32 s53, 17858560
    buffer_load_dword v22, v4, s[32:35], s53 offen sc1
    s_mov_b32 s53, 17866752
    buffer_load_dword v23, v4, s[32:35], s53 offen sc1
    s_waitcnt vmcnt(0) lgkmcnt(0)
    s_branch sequential_preLN__ssm_conv_s4d__glu_gated_swiglu__prompt_kernel_wlp228
sequential_preLN__ssm_conv_s4d__glu_gated_swiglu__prompt_kernel_wok27:
sequential_preLN__ssm_conv_s4d__glu_gated_swiglu__prompt_kernel_cjz24:
    s_and_b32 s52, s2, 3
    s_bfe_u32 s53, s2, 0x10002
    s_bfe_u32 s54, s2, 0x20003
    s_lshr_b32 s55, s2, 5
    s_lshl_b32 s72, s52, 2
    s_add_u32 s72, s72, s54
    s_mul_i32 s73, s53, 7
    s_add_u32 s73, s73, s55
    s_lshl_b32 s74, s73, 2
    s_add_u32 s74, s74, s3
    s_lshl_b32 s75, s72, 1
    s_add_u32 s75, s75, s53
    s_mov_b32 s76, s55
    v_and_b32 v5, 15, v1
    v_lshrrev_b32_e64 v5, 2, v5
    v_lshl_add_u32 v7, v3, 3, v5
    v_lshlrev_b32_e64 v7, 7, v7
    v_bfe_u32 v240, v1, 4, 1
    v_lshl_add_u32 v7, v240, 5, v7
    v_and_b32_e64 v240, 3, v1
    v_lshl_add_u32 v7, v240, 3, v7
    v_lshrrev_b32 v5, 1, v5
    v_xor_b32 v240, 0, v5
    v_lshl_add_u32 v8, v240, 6, v7
    v_add_u32 v10, 57344, v8
    v_xor_b32_e64 v240, 1, v5
    v_lshl_add_u32 v9, v240, 6, v7
    v_add_u32 v11, 57344, v9
    v_lshrrev_b32_e64 v6, 3, v1
    v_bfe_u32 v4, v1, 2, 1
    v_bfe_u32 v5, v1, 4, 1
    v_xor_b32 v4, v4, v5
    v_lshlrev_b32 v4, 6, v4
    v_lshl_add_u32 v4, v6, 12, v4
    v_and_b32_e64 v6, 3, v1
    v_lshl_add_u32 v16, v6, 4, v4
    s_mul_i32 s78, s74, 57344
    s_add_u32 s78, s78, 5505024
    buffer_load_dwordx4 a[0:3], v2, s[32:35], s78 offen offset:0 sc1
    buffer_load_dwordx4 a[4:7], v2, s[32:35], s78 offen offset:1024 sc1
    buffer_load_dwordx4 a[8:11], v2, s[32:35], s78 offen offset:2048 sc1
    buffer_load_dwordx4 a[12:15], v2, s[32:35], s78 offen offset:3072 sc1
    s_add_u32 s78, s78, 4096
    buffer_load_dwordx4 a[16:19], v2, s[32:35], s78 offen offset:0 sc1
    buffer_load_dwordx4 a[20:23], v2, s[32:35], s78 offen offset:1024 sc1
    buffer_load_dwordx4 a[24:27], v2, s[32:35], s78 offen offset:2048 sc1
    buffer_load_dwordx4 a[28:31], v2, s[32:35], s78 offen offset:3072 sc1
    s_add_u32 s78, s78, 4096
    v_lshlrev_b32_e64 v17, 7, v1
    v_add_u32 v17, 17661952, v17
    v_mov_b32 v18, 7
    s_mov_b32 exec_lo, 0xffffffff
    s_mov_b32 exec_hi, 0
    global_load_dword v19, v17, s[30:31] sc1
    s_mov_b64 exec, -1
    s_waitcnt vmcnt(9)
    s_barrier
    s_and_b32 s52, s2, 31
    s_lshl_b32 s52, s52, 7
    s_add_u32 s52, s52, 17666048
    s_cmp_lg_u32 s3, 0
    s_cbranch_scc1 sequential_preLN__ssm_conv_s4d__glu_gated_swiglu__prompt_kernel_arr29
    v_mov_b32 v4, s52
    v_mov_b32 v5, 1
    s_mov_b64 exec, 1
    global_atomic_add v4, v5, s[30:31]
    s_mov_b64 exec, -1
sequential_preLN__ssm_conv_s4d__glu_gated_swiglu__prompt_kernel_arr29:
    s_mov_b32 exec_lo, 0xffffffff
    s_mov_b32 exec_hi, 0
    s_waitcnt vmcnt(0)
    v_cmp_gt_u32 vcc, v18, v19
    s_mov_b64 exec, -1
    s_nop 3
    s_cmp_eq_u64 vcc, 0
    s_cbranch_scc1 sequential_preLN__ssm_conv_s4d__glu_gated_swiglu__prompt_kernel_cok30
    s_mov_b32 exec_lo, 0xffffffff
    s_mov_b32 exec_hi, 0
    s_mov_b32 s52, 0
sequential_preLN__ssm_conv_s4d__glu_gated_swiglu__prompt_kernel_clp31:
    global_load_dword v19, v17, s[30:31] sc1
    s_add_u32 s52, s52, 1
    s_waitcnt vmcnt(0) lgkmcnt(0)
    v_cmp_gt_u32 vcc, v18, v19
    s_cmp_ge_u32 s52, 400000
    s_nop 3
    s_cbranch_scc1 sequential_preLN__ssm_conv_s4d__glu_gated_swiglu__prompt_kernel_cex32
    s_nop 3
    s_cmp_eq_u64 vcc, 0
    s_cbranch_scc0 sequential_preLN__ssm_conv_s4d__glu_gated_swiglu__prompt_kernel_clp31
sequential_preLN__ssm_conv_s4d__glu_gated_swiglu__prompt_kernel_cex32:
    s_mov_b64 exec, -1
sequential_preLN__ssm_conv_s4d__glu_gated_swiglu__prompt_kernel_cok30:
    s_lshl_b32 s60, s3, 15
    s_lshl_b32 s63, s72, 7
    s_add_u32 s60, s60, s63
    s_add_u32 s60, s60, 3670016
    s_lshl_b32 s61, s3, 10
    s_mov_b32 m0, s61
    s_nop 0
    buffer_load_dwordx4 v16, s[32:35], s60 offen sc1 lds
    s_add_u32 s61, s61, 4096
    s_add_u32 s60, s60, 131072
    s_mov_b32 m0, s61
    s_nop 0
    buffer_load_dwordx4 v16, s[32:35], s60 offen sc1 lds
    s_add_u32 s61, s61, 4096
    s_add_u32 s60, s60, 131072
    s_mov_b32 m0, s61
    s_nop 0
    buffer_load_dwordx4 v16, s[32:35], s60 offen sc1 lds
    s_add_u32 s61, s61, 4096
    s_add_u32 s60, s60, 131072
    s_mov_b32 m0, s61
    s_nop 0
    buffer_load_dwordx4 v16, s[32:35], s60 offen sc1 lds
    s_add_u32 s61, s61, 4096
    s_add_u32 s60, s60, 131072
    s_mov_b32 m0, s61
    s_nop 0
    buffer_load_dwordx4 v16, s[32:35], s60 offen sc1 lds
    s_add_u32 s61, s61, 4096
    s_add_u32 s60, s60, 131072
    s_mov_b32 m0, s61
    s_nop 0
    buffer_load_dwordx4 v16, s[32:35], s60 offen sc1 lds
    s_add_u32 s61, s61, 4096
    s_add_u32 s60, s60, 131072
    s_mov_b32 m0, s61
    s_nop 0
    buffer_load_dwordx4 v16, s[32:35], s60 offen sc1 lds
    s_add_u32 s61, s61, 4096
    s_add_u32 s60, s60, 131072
    s_mov_b32 m0, s61
    s_nop 0
    buffer_load_dwordx4 v16, s[32:35], s60 offen sc1 lds
    s_add_u32 s61, s61, 4096
    s_add_u32 s60, s60, 131072
    s_mov_b32 m0, s61
    s_nop 0
    buffer_load_dwordx4 v16, s[32:35], s60 offen sc1 lds
    s_add_u32 s61, s61, 4096
    s_add_u32 s60, s60, 131072
    s_mov_b32 m0, s61
    s_nop 0
    buffer_load_dwordx4 v16, s[32:35], s60 offen sc1 lds
    s_add_u32 s61, s61, 4096
    s_add_u32 s60, s60, 131072
    s_mov_b32 m0, s61
    s_nop 0
    buffer_load_dwordx4 v16, s[32:35], s60 offen sc1 lds
    s_add_u32 s61, s61, 4096
    s_add_u32 s60, s60, 131072
    s_mov_b32 m0, s61
    s_nop 0
    buffer_load_dwordx4 v16, s[32:35], s60 offen sc1 lds
    s_add_u32 s61, s61, 4096
    s_add_u32 s60, s60, 131072
    s_mov_b32 m0, s61
    s_nop 0
    buffer_load_dwordx4 v16, s[32:35], s60 offen sc1 lds
    s_add_u32 s61, s61, 4096
    s_add_u32 s60, s60, 131072
    s_mov_b32 m0, s61
    s_nop 0
    buffer_load_dwordx4 v16, s[32:35], s60 offen sc1 lds
    s_mul_i32 s78, s74, 57344
    s_add_u32 s78, s78, 5513216
    buffer_load_dwordx4 a[32:35], v2, s[32:35], s78 offen offset:0 sc1
    buffer_load_dwordx4 a[36:39], v2, s[32:35], s78 offen offset:1024 sc1
    buffer_load_dwordx4 a[40:43], v2, s[32:35], s78 offen offset:2048 sc1
    buffer_load_dwordx4 a[44:47], v2, s[32:35], s78 offen offset:3072 sc1
    s_add_u32 s78, s78, 4096
    buffer_load_dwordx4 a[48:51], v2, s[32:35], s78 offen offset:0 sc1
    buffer_load_dwordx4 a[52:55], v2, s[32:35], s78 offen offset:1024 sc1
    buffer_load_dwordx4 a[56:59], v2, s[32:35], s78 offen offset:2048 sc1
    buffer_load_dwordx4 a[60:63], v2, s[32:35], s78 offen offset:3072 sc1
    s_add_u32 s78, s78, 4096
    buffer_load_dwordx4 a[64:67], v2, s[32:35], s78 offen offset:0 sc1
    buffer_load_dwordx4 a[68:71], v2, s[32:35], s78 offen offset:1024 sc1
    buffer_load_dwordx4 a[72:75], v2, s[32:35], s78 offen offset:2048 sc1
    buffer_load_dwordx4 a[76:79], v2, s[32:35], s78 offen offset:3072 sc1
    s_add_u32 s78, s78, 4096
    buffer_load_dwordx4 a[80:83], v2, s[32:35], s78 offen offset:0 sc1
    buffer_load_dwordx4 a[84:87], v2, s[32:35], s78 offen offset:1024 sc1
    buffer_load_dwordx4 a[88:91], v2, s[32:35], s78 offen offset:2048 sc1
    buffer_load_dwordx4 a[92:95], v2, s[32:35], s78 offen offset:3072 sc1
    s_add_u32 s78, s78, 4096
    buffer_load_dwordx4 a[96:99], v2, s[32:35], s78 offen offset:0 sc1
    buffer_load_dwordx4 a[100:103], v2, s[32:35], s78 offen offset:1024 sc1
    buffer_load_dwordx4 a[104:107], v2, s[32:35], s78 offen offset:2048 sc1
    buffer_load_dwordx4 a[108:111], v2, s[32:35], s78 offen offset:3072 sc1
    s_add_u32 s78, s78, 4096
    buffer_load_dwordx4 a[112:115], v2, s[32:35], s78 offen offset:0 sc1
    buffer_load_dwordx4 a[116:119], v2, s[32:35], s78 offen offset:1024 sc1
    buffer_load_dwordx4 a[120:123], v2, s[32:35], s78 offen offset:2048 sc1
    buffer_load_dwordx4 a[124:127], v2, s[32:35], s78 offen offset:3072 sc1
    s_add_u32 s78, s78, 4096
    s_mul_i32 s62, s76, 112
    s_mul_i32 s63, s3, 28
    s_add_u32 s62, s62, s63
    s_lshl_b32 s62, s62, 11
    s_add_u32 s62, s62, 8716288
    s_lshl_b32 s64, s72, 1
    s_mul_i32 s64, s64, 112
    s_lshl_b32 s63, s74, 1
    s_add_u32 s64, s64, s63
    s_lshl_b32 s64, s64, 10
    s_add_u32 s64, s64, 10321920
    s_waitcnt vmcnt(34)
    s_barrier
    v_lshlrev_b32 v20, 7, v1
    v_add_u32 v20, 17666048, v20
    v_mov_b32 v21, 7
    s_mov_b32 exec_lo, 0xffffffff
    s_mov_b32 exec_hi, 0
    global_load_dword v22, v20, s[30:31] sc1
    s_mov_b64 exec, -1
    ds_read_b64_tr_b16 v[24:25], v8 offset:0
    ds_read_b64_tr_b16 v[26:27], v8 offset:512
    ds_read_b64_tr_b16 v[28:29], v9 offset:0
    ds_read_b64_tr_b16 v[30:31], v9 offset:512
    ds_read_b64_tr_b16 v[32:33], v8 offset:2048
    ds_read_b64_tr_b16 v[34:35], v8 offset:2560
    ds_read_b64_tr_b16 v[36:37], v9 offset:2048
    ds_read_b64_tr_b16 v[38:39], v9 offset:2560
    s_waitcnt lgkmcnt(6)
    v_mfma_f32_32x32x16_bf16 v[64:79], a[0:3], v[24:27], 0
    ds_read_b64_tr_b16 v[40:41], v8 offset:4096
    v_mfma_f32_32x32x16_bf16 v[80:95], a[4:7], v[24:27], 0
    ds_read_b64_tr_b16 v[42:43], v8 offset:4608
    s_waitcnt lgkmcnt(6)
    v_mfma_f32_32x32x16_bf16 v[96:111], a[0:3], v[28:31], 0
    s_mul_i32 s78, s74, 57344
    ds_read_b64_tr_b16 v[44:45], v9 offset:4096
    v_mfma_f32_32x32x16_bf16 v[112:127], a[4:7], v[28:31], 0
    ds_read_b64_tr_b16 v[46:47], v9 offset:4608
    s_waitcnt lgkmcnt(6)
    v_mfma_f32_32x32x16_bf16 v[64:79], a[8:11], v[32:35], v[64:79]
    s_add_u32 s78, s78, 5537792
    ds_read_b64_tr_b16 v[24:25], v8 offset:6144
    v_mfma_f32_32x32x16_bf16 v[80:95], a[12:15], v[32:35], v[80:95]
    ds_read_b64_tr_b16 v[26:27], v8 offset:6656
    s_waitcnt lgkmcnt(6)
    v_mfma_f32_32x32x16_bf16 v[96:111], a[8:11], v[36:39], v[96:111]
    buffer_load_dwordx4 a[128:131], v2, s[32:35], s78 offen offset:0 sc1
    ds_read_b64_tr_b16 v[28:29], v9 offset:6144
    v_mfma_f32_32x32x16_bf16 v[112:127], a[12:15], v[36:39], v[112:127]
    ds_read_b64_tr_b16 v[30:31], v9 offset:6656
    s_waitcnt lgkmcnt(6)
    v_mfma_f32_32x32x16_bf16 v[64:79], a[16:19], v[40:43], v[64:79]
    buffer_load_dwordx4 a[132:135], v2, s[32:35], s78 offen offset:1024 sc1
    ds_read_b64_tr_b16 v[32:33], v8 offset:8192
    v_mfma_f32_32x32x16_bf16 v[80:95], a[20:23], v[40:43], v[80:95]
    ds_read_b64_tr_b16 v[34:35], v8 offset:8704
    s_waitcnt lgkmcnt(6)
    v_mfma_f32_32x32x16_bf16 v[96:111], a[16:19], v[44:47], v[96:111]
    buffer_load_dwordx4 a[136:139], v2, s[32:35], s78 offen offset:2048 sc1
    ds_read_b64_tr_b16 v[36:37], v9 offset:8192
    v_mfma_f32_32x32x16_bf16 v[112:127], a[20:23], v[44:47], v[112:127]
    ds_read_b64_tr_b16 v[38:39], v9 offset:8704
    s_waitcnt lgkmcnt(6)
    v_mfma_f32_32x32x16_bf16 v[64:79], a[24:27], v[24:27], v[64:79]
    buffer_load_dwordx4 a[140:143], v2, s[32:35], s78 offen offset:3072 sc1
    ds_read_b64_tr_b16 v[40:41], v8 offset:10240
    v_mfma_f32_32x32x16_bf16 v[80:95], a[28:31], v[24:27], v[80:95]
    ds_read_b64_tr_b16 v[42:43], v8 offset:10752
    s_waitcnt lgkmcnt(6)
    v_mfma_f32_32x32x16_bf16 v[96:111], a[24:27], v[28:31], v[96:111]
    s_add_u32 s78, s78, 4096
    ds_read_b64_tr_b16 v[44:45], v9 offset:10240
    v_mfma_f32_32x32x16_bf16 v[112:127], a[28:31], v[28:31], v[112:127]
    ds_read_b64_tr_b16 v[46:47], v9 offset:10752
    s_waitcnt vmcnt(28) lgkmcnt(6)
    v_mfma_f32_32x32x16_bf16 v[64:79], a[32:35], v[32:35], v[64:79]
    ds_read_b64_tr_b16 v[24:25], v8 offset:12288
    s_waitcnt vmcnt(27)
    v_mfma_f32_32x32x16_bf16 v[80:95], a[36:39], v[32:35], v[80:95]
    buffer_load_dwordx4 a[144:147], v2, s[32:35], s78 offen offset:0 sc1
    ds_read_b64_tr_b16 v[26:27], v8 offset:12800
    s_waitcnt lgkmcnt(6)
    v_mfma_f32_32x32x16_bf16 v[96:111], a[32:35], v[36:39], v[96:111]
    ds_read_b64_tr_b16 v[28:29], v9 offset:12288
    v_mfma_f32_32x32x16_bf16 v[112:127], a[36:39], v[36:39], v[112:127]
    buffer_load_dwordx4 a[148:151], v2, s[32:35], s78 offen offset:1024 sc1
    ds_read_b64_tr_b16 v[30:31], v9 offset:12800
    s_waitcnt vmcnt(28) lgkmcnt(6)
    v_mfma_f32_32x32x16_bf16 v[64:79], a[40:43], v[40:43], v[64:79]
    ds_read_b64_tr_b16 v[32:33], v8 offset:14336
    s_waitcnt vmcnt(27)
    v_mfma_f32_32x32x16_bf16 v[80:95], a[44:47], v[40:43], v[80:95]
    buffer_load_dwordx4 a[152:155], v2, s[32:35], s78 offen offset:2048 sc1
    ds_read_b64_tr_b16 v[34:35], v8 offset:14848
    s_waitcnt lgkmcnt(6)
    v_mfma_f32_32x32x16_bf16 v[96:111], a[40:43], v[44:47], v[96:111]
    ds_read_b64_tr_b16 v[36:37], v9 offset:14336
    v_mfma_f32_32x32x16_bf16 v[112:127], a[44:47], v[44:47], v[112:127]
    buffer_load_dwordx4 a[156:159], v2, s[32:35], s78 offen offset:3072 sc1
    ds_read_b64_tr_b16 v[38:39], v9 offset:14848
    s_waitcnt vmcnt(28) lgkmcnt(6)
    v_mfma_f32_32x32x16_bf16 v[64:79], a[48:51], v[24:27], v[64:79]
    s_waitcnt vmcnt(27)
    v_mfma_f32_32x32x16_bf16 v[80:95], a[52:55], v[24:27], v[80:95]
    s_add_u32 s78, s78, 4096
    s_waitcnt lgkmcnt(4)
    v_mfma_f32_32x32x16_bf16 v[96:111], a[48:51], v[28:31], v[96:111]
    v_mfma_f32_32x32x16_bf16 v[112:127], a[52:55], v[28:31], v[112:127]
    buffer_load_dwordx4 a[160:163], v2, s[32:35], s78 offen offset:0 sc1
    s_waitcnt vmcnt(27) lgkmcnt(2)
    v_mfma_f32_32x32x16_bf16 v[64:79], a[56:59], v[32:35], v[64:79]
    s_waitcnt vmcnt(26)
    v_mfma_f32_32x32x16_bf16 v[80:95], a[60:63], v[32:35], v[80:95]
    buffer_load_dwordx4 a[164:167], v2, s[32:35], s78 offen offset:1024 sc1
    s_waitcnt lgkmcnt(0)
    v_mfma_f32_32x32x16_bf16 v[96:111], a[56:59], v[36:39], v[96:111]
    v_mfma_f32_32x32x16_bf16 v[112:127], a[60:63], v[36:39], v[112:127]
    buffer_load_dwordx4 a[168:171], v2, s[32:35], s78 offen offset:2048 sc1
    buffer_load_dwordx4 a[172:175], v2, s[32:35], s78 offen offset:3072 sc1
    s_barrier
    s_mov_b32 exec_lo, 0xffffffff
    s_mov_b32 exec_hi, 0
    s_waitcnt vmcnt(12)
    v_cmp_gt_u32 vcc, v21, v22
    s_mov_b64 exec, -1
    s_nop 3
    s_cmp_eq_u64 vcc, 0
    s_cbranch_scc1 sequential_preLN__ssm_conv_s4d__glu_gated_swiglu__prompt_kernel_cok33
    s_mov_b32 exec_lo, 0xffffffff
    s_mov_b32 exec_hi, 0
    s_mov_b32 s52, 0
sequential_preLN__ssm_conv_s4d__glu_gated_swiglu__prompt_kernel_clp34:
    global_load_dword v22, v20, s[30:31] sc1
    s_add_u32 s52, s52, 1
    s_waitcnt vmcnt(0) lgkmcnt(0)
    v_cmp_gt_u32 vcc, v21, v22
    s_cmp_ge_u32 s52, 400000
    s_nop 3
    s_cbranch_scc1 sequential_preLN__ssm_conv_s4d__glu_gated_swiglu__prompt_kernel_cex35
    s_nop 3
    s_cmp_eq_u64 vcc, 0
    s_cbranch_scc0 sequential_preLN__ssm_conv_s4d__glu_gated_swiglu__prompt_kernel_clp34
sequential_preLN__ssm_conv_s4d__glu_gated_swiglu__prompt_kernel_cex35:
    s_mov_b64 exec, -1
sequential_preLN__ssm_conv_s4d__glu_gated_swiglu__prompt_kernel_cok33:
    ds_read_b64_tr_b16 v[40:41], v8 offset:16384
    ds_read_b64_tr_b16 v[42:43], v8 offset:16896
    ds_read_b64_tr_b16 v[44:45], v9 offset:16384
    ds_read_b64_tr_b16 v[46:47], v9 offset:16896
    ds_read_b64_tr_b16 v[24:25], v8 offset:18432
    ds_read_b64_tr_b16 v[26:27], v8 offset:18944
    ds_read_b64_tr_b16 v[28:29], v9 offset:18432
    ds_read_b64_tr_b16 v[30:31], v9 offset:18944
    s_waitcnt lgkmcnt(6)
    v_mfma_f32_32x32x16_bf16 v[64:79], a[64:67], v[40:43], v[64:79]
    s_add_u32 s78, s78, 4096
    ds_read_b64_tr_b16 v[32:33], v8 offset:20480
    v_mfma_f32_32x32x16_bf16 v[80:95], a[68:71], v[40:43], v[80:95]
    buffer_load_dwordx4 a[176:179], v2, s[32:35], s78 offen offset:0 sc1
    ds_read_b64_tr_b16 v[34:35], v8 offset:20992
    s_waitcnt lgkmcnt(6)
    v_mfma_f32_32x32x16_bf16 v[96:111], a[64:67], v[44:47], v[96:111]
    buffer_load_dwordx4 a[180:183], v2, s[32:35], s78 offen offset:1024 sc1
    ds_read_b64_tr_b16 v[36:37], v9 offset:20480
    v_mfma_f32_32x32x16_bf16 v[112:127], a[68:71], v[44:47], v[112:127]
    buffer_load_dwordx4 a[184:187], v2, s[32:35], s78 offen offset:2048 sc1
    buffer_load_dwordx4 a[188:191], v2, s[32:35], s78 offen offset:3072 sc1
    ds_read_b64_tr_b16 v[38:39], v9 offset:20992
    s_waitcnt lgkmcnt(6)
    v_mfma_f32_32x32x16_bf16 v[64:79], a[72:75], v[24:27], v[64:79]
    s_add_u32 s78, s78, 4096
    ds_read_b64_tr_b16 v[40:41], v8 offset:22528
    v_mfma_f32_32x32x16_bf16 v[80:95], a[76:79], v[24:27], v[80:95]
    buffer_load_dwordx4 a[192:195], v2, s[32:35], s78 offen offset:0 sc1
    ds_read_b64_tr_b16 v[42:43], v8 offset:23040
    s_waitcnt lgkmcnt(6)
    v_mfma_f32_32x32x16_bf16 v[96:111], a[72:75], v[28:31], v[96:111]
    buffer_load_dwordx4 a[196:199], v2, s[32:35], s78 offen offset:1024 sc1
    ds_read_b64_tr_b16 v[44:45], v9 offset:22528
    v_mfma_f32_32x32x16_bf16 v[112:127], a[76:79], v[28:31], v[112:127]
    buffer_load_dwordx4 a[200:203], v2, s[32:35], s78 offen offset:2048 sc1
    buffer_load_dwordx4 a[204:207], v2, s[32:35], s78 offen offset:3072 sc1
    ds_read_b64_tr_b16 v[46:47], v9 offset:23040
    s_waitcnt lgkmcnt(6)
    v_mfma_f32_32x32x16_bf16 v[64:79], a[80:83], v[32:35], v[64:79]
    s_add_u32 s78, s78, 4096
    ds_read_b64_tr_b16 v[24:25], v8 offset:24576
    v_mfma_f32_32x32x16_bf16 v[80:95], a[84:87], v[32:35], v[80:95]
    buffer_load_dwordx4 a[208:211], v2, s[32:35], s78 offen offset:0 sc1
    ds_read_b64_tr_b16 v[26:27], v8 offset:25088
    s_waitcnt lgkmcnt(6)
    v_mfma_f32_32x32x16_bf16 v[96:111], a[80:83], v[36:39], v[96:111]
    buffer_load_dwordx4 a[212:215], v2, s[32:35], s78 offen offset:1024 sc1
    ds_read_b64_tr_b16 v[28:29], v9 offset:24576
    v_mfma_f32_32x32x16_bf16 v[112:127], a[84:87], v[36:39], v[112:127]
    buffer_load_dwordx4 a[216:219], v2, s[32:35], s78 offen offset:2048 sc1
    buffer_load_dwordx4 a[220:223], v2, s[32:35], s78 offen offset:3072 sc1
    ds_read_b64_tr_b16 v[30:31], v9 offset:25088
    s_waitcnt lgkmcnt(6)
    v_mfma_f32_32x32x16_bf16 v[64:79], a[88:91], v[40:43], v[64:79]
    s_add_u32 s78, s78, 4096
    ds_read_b64_tr_b16 v[32:33], v8 offset:26624
    v_mfma_f32_32x32x16_bf16 v[80:95], a[92:95], v[40:43], v[80:95]
    s_lshl_b32 s60, s3, 15
    ds_read_b64_tr_b16 v[34:35], v8 offset:27136
    s_waitcnt lgkmcnt(6)
    v_mfma_f32_32x32x16_bf16 v[96:111], a[88:91], v[44:47], v[96:111]
    s_lshl_b32 s63, s72, 7
    ds_read_b64_tr_b16 v[36:37], v9 offset:26624
    v_mfma_f32_32x32x16_bf16 v[112:127], a[92:95], v[44:47], v[112:127]
    s_add_u32 s60, s60, s63
    s_add_u32 s60, s60, 3672064
    ds_read_b64_tr_b16 v[38:39], v9 offset:27136
    s_waitcnt lgkmcnt(6)
    v_mfma_f32_32x32x16_bf16 v[64:79], a[96:99], v[24:27], v[64:79]
    s_lshl_b32 s61, s3, 10
    ds_read_b64_tr_b16 v[40:41], v8 offset:28672
    v_mfma_f32_32x32x16_bf16 v[80:95], a[100:103], v[24:27], v[80:95]
    s_add_u32 s61, s61, 57344
    ds_read_b64_tr_b16 v[42:43], v8 offset:29184
    s_waitcnt lgkmcnt(6)
    v_mfma_f32_32x32x16_bf16 v[96:111], a[96:99], v[28:31], v[96:111]
    s_mov_b32 m0, s61
    s_nop 0
    buffer_load_dwordx4 v16, s[32:35], s60 offen sc1 lds
    ds_read_b64_tr_b16 v[44:45], v9 offset:28672
    v_mfma_f32_32x32x16_bf16 v[112:127], a[100:103], v[28:31], v[112:127]
    s_add_u32 s61, s61, 4096
    ds_read_b64_tr_b16 v[46:47], v9 offset:29184
    s_waitcnt lgkmcnt(6)
    v_mfma_f32_32x32x16_bf16 v[64:79], a[104:107], v[32:35], v[64:79]
    s_add_u32 s60, s60, 131072
    ds_read_b64_tr_b16 v[24:25], v8 offset:30720
    v_mfma_f32_32x32x16_bf16 v[80:95], a[108:111], v[32:35], v[80:95]
    s_mov_b32 m0, s61
    ds_read_b64_tr_b16 v[26:27], v8 offset:31232
    s_waitcnt lgkmcnt(6)
    v_mfma_f32_32x32x16_bf16 v[96:111], a[104:107], v[36:39], v[96:111]
    buffer_load_dwordx4 v16, s[32:35], s60 offen sc1 lds
    s_add_u32 s61, s61, 4096
    ds_read_b64_tr_b16 v[28:29], v9 offset:30720
    v_mfma_f32_32x32x16_bf16 v[112:127], a[108:111], v[36:39], v[112:127]
    s_add_u32 s60, s60, 131072
    ds_read_b64_tr_b16 v[30:31], v9 offset:31232
    s_waitcnt lgkmcnt(6)
    v_mfma_f32_32x32x16_bf16 v[64:79], a[112:115], v[40:43], v[64:79]
    s_mov_b32 m0, s61
    v_mfma_f32_32x32x16_bf16 v[80:95], a[116:119], v[40:43], v[80:95]
    buffer_load_dwordx4 v16, s[32:35], s60 offen sc1 lds
    s_waitcnt lgkmcnt(4)
    v_mfma_f32_32x32x16_bf16 v[96:111], a[112:115], v[44:47], v[96:111]
    s_add_u32 s61, s61, 4096
    s_add_u32 s60, s60, 131072
    v_mfma_f32_32x32x16_bf16 v[112:127], a[116:119], v[44:47], v[112:127]
    s_mov_b32 m0, s61
    s_waitcnt lgkmcnt(2)
    v_mfma_f32_32x32x16_bf16 v[64:79], a[120:123], v[24:27], v[64:79]
    buffer_load_dwordx4 v16, s[32:35], s60 offen sc1 lds
    v_mfma_f32_32x32x16_bf16 v[80:95], a[124:127], v[24:27], v[80:95]
    s_add_u32 s61, s61, 4096
    s_waitcnt lgkmcnt(0)
    v_mfma_f32_32x32x16_bf16 v[96:111], a[120:123], v[28:31], v[96:111]
    s_add_u32 s60, s60, 131072
    v_mfma_f32_32x32x16_bf16 v[112:127], a[124:127], v[28:31], v[112:127]
    s_barrier
    ds_read_b64_tr_b16 v[32:33], v8 offset:32768
    ds_read_b64_tr_b16 v[34:35], v8 offset:33280
    ds_read_b64_tr_b16 v[36:37], v9 offset:32768
    ds_read_b64_tr_b16 v[38:39], v9 offset:33280
    ds_read_b64_tr_b16 v[40:41], v8 offset:34816
    ds_read_b64_tr_b16 v[42:43], v8 offset:35328
    ds_read_b64_tr_b16 v[44:45], v9 offset:34816
    ds_read_b64_tr_b16 v[46:47], v9 offset:35328
    s_waitcnt vmcnt(27) lgkmcnt(6)
    v_mfma_f32_32x32x16_bf16 v[64:79], a[128:131], v[32:35], v[64:79]
    s_mov_b32 m0, s61
    ds_read_b64_tr_b16 v[24:25], v8 offset:36864
    s_waitcnt vmcnt(26)
    v_mfma_f32_32x32x16_bf16 v[80:95], a[132:135], v[32:35], v[80:95]
    buffer_load_dwordx4 v16, s[32:35], s60 offen sc1 lds
    ds_read_b64_tr_b16 v[26:27], v8 offset:37376
    s_waitcnt lgkmcnt(6)
    v_mfma_f32_32x32x16_bf16 v[96:111], a[128:131], v[36:39], v[96:111]
    s_add_u32 s61, s61, 4096
    ds_read_b64_tr_b16 v[28:29], v9 offset:36864
    v_mfma_f32_32x32x16_bf16 v[112:127], a[132:135], v[36:39], v[112:127]
    s_add_u32 s60, s60, 131072
    s_mov_b32 m0, s61
    ds_read_b64_tr_b16 v[30:31], v9 offset:37376
    s_waitcnt vmcnt(26) lgkmcnt(6)
    v_mfma_f32_32x32x16_bf16 v[64:79], a[136:139], v[40:43], v[64:79]
    buffer_load_dwordx4 v16, s[32:35], s60 offen sc1 lds
    ds_read_b64_tr_b16 v[32:33], v8 offset:38912
    s_waitcnt vmcnt(26)
    v_mfma_f32_32x32x16_bf16 v[80:95], a[140:143], v[40:43], v[80:95]
    s_add_u32 s61, s61, 4096
    ds_read_b64_tr_b16 v[34:35], v8 offset:39424
    s_waitcnt lgkmcnt(6)
    v_mfma_f32_32x32x16_bf16 v[96:111], a[136:139], v[44:47], v[96:111]
    s_add_u32 s60, s60, 131072
    s_mov_b32 m0, s61
    ds_read_b64_tr_b16 v[36:37], v9 offset:38912
    v_mfma_f32_32x32x16_bf16 v[112:127], a[140:143], v[44:47], v[112:127]
    buffer_load_dwordx4 v16, s[32:35], s60 offen sc1 lds
    ds_read_b64_tr_b16 v[38:39], v9 offset:39424
    s_waitcnt vmcnt(26) lgkmcnt(6)
    v_mfma_f32_32x32x16_bf16 v[64:79], a[144:147], v[24:27], v[64:79]
    s_add_u32 s61, s61, 4096
    ds_read_b64_tr_b16 v[40:41], v8 offset:40960
    s_waitcnt vmcnt(25)
    v_mfma_f32_32x32x16_bf16 v[80:95], a[148:151], v[24:27], v[80:95]
    s_add_u32 s60, s60, 131072
    s_mov_b32 m0, s61
    ds_read_b64_tr_b16 v[42:43], v8 offset:41472
    s_waitcnt lgkmcnt(6)
    v_mfma_f32_32x32x16_bf16 v[96:111], a[144:147], v[28:31], v[96:111]
    buffer_load_dwordx4 v16, s[32:35], s60 offen sc1 lds
    ds_read_b64_tr_b16 v[44:45], v9 offset:40960
    v_mfma_f32_32x32x16_bf16 v[112:127], a[148:151], v[28:31], v[112:127]
    s_add_u32 s61, s61, 4096
    ds_read_b64_tr_b16 v[46:47], v9 offset:41472
    s_waitcnt vmcnt(25) lgkmcnt(6)
    v_mfma_f32_32x32x16_bf16 v[64:79], a[152:155], v[32:35], v[64:79]
    s_add_u32 s60, s60, 131072
    ds_read_b64_tr_b16 v[24:25], v8 offset:43008
    s_waitcnt vmcnt(24)
    v_mfma_f32_32x32x16_bf16 v[80:95], a[156:159], v[32:35], v[80:95]
    s_mov_b32 m0, s61
    s_nop 0
    buffer_load_dwordx4 v16, s[32:35], s60 offen sc1 lds
    ds_read_b64_tr_b16 v[26:27], v8 offset:43520
    s_waitcnt lgkmcnt(6)
    v_mfma_f32_32x32x16_bf16 v[96:111], a[152:155], v[36:39], v[96:111]
    s_add_u32 s61, s61, 4096
    ds_read_b64_tr_b16 v[28:29], v9 offset:43008
    v_mfma_f32_32x32x16_bf16 v[112:127], a[156:159], v[36:39], v[112:127]
    s_add_u32 s60, s60, 131072
    ds_read_b64_tr_b16 v[30:31], v9 offset:43520
    s_waitcnt vmcnt(24) lgkmcnt(6)
    v_mfma_f32_32x32x16_bf16 v[64:79], a[160:163], v[40:43], v[64:79]
    s_mov_b32 m0, s61
    s_nop 0
    buffer_load_dwordx4 v16, s[32:35], s60 offen sc1 lds
    ds_read_b64_tr_b16 v[32:33], v8 offset:45056
    s_waitcnt vmcnt(24)
    v_mfma_f32_32x32x16_bf16 v[80:95], a[164:167], v[40:43], v[80:95]
    s_add_u32 s61, s61, 4096
    ds_read_b64_tr_b16 v[34:35], v8 offset:45568
    s_waitcnt lgkmcnt(6)
    v_mfma_f32_32x32x16_bf16 v[96:111], a[160:163], v[44:47], v[96:111]
    s_add_u32 s60, s60, 131072
    ds_read_b64_tr_b16 v[36:37], v9 offset:45056
    v_mfma_f32_32x32x16_bf16 v[112:127], a[164:167], v[44:47], v[112:127]
    s_mov_b32 m0, s61
    s_nop 0
    buffer_load_dwordx4 v16, s[32:35], s60 offen sc1 lds
    ds_read_b64_tr_b16 v[38:39], v9 offset:45568
    s_waitcnt vmcnt(24) lgkmcnt(6)
    v_mfma_f32_32x32x16_bf16 v[64:79], a[168:171], v[24:27], v[64:79]
    s_add_u32 s61, s61, 4096
    ds_read_b64_tr_b16 v[40:41], v8 offset:47104
    s_waitcnt vmcnt(23)
    v_mfma_f32_32x32x16_bf16 v[80:95], a[172:175], v[24:27], v[80:95]
    s_add_u32 s60, s60, 131072
    ds_read_b64_tr_b16 v[42:43], v8 offset:47616
    s_waitcnt lgkmcnt(6)
    v_mfma_f32_32x32x16_bf16 v[96:111], a[168:171], v[28:31], v[96:111]
    s_mov_b32 m0, s61
    ds_read_b64_tr_b16 v[44:45], v9 offset:47104
    v_mfma_f32_32x32x16_bf16 v[112:127], a[172:175], v[28:31], v[112:127]
    buffer_load_dwordx4 v16, s[32:35], s60 offen sc1 lds
    s_add_u32 s61, s61, 4096
    ds_read_b64_tr_b16 v[46:47], v9 offset:47616
    s_waitcnt vmcnt(23) lgkmcnt(6)
    v_mfma_f32_32x32x16_bf16 v[64:79], a[176:179], v[32:35], v[64:79]
    s_add_u32 s60, s60, 131072
    s_waitcnt vmcnt(22)
    v_mfma_f32_32x32x16_bf16 v[80:95], a[180:183], v[32:35], v[80:95]
    s_mov_b32 m0, s61
    s_waitcnt lgkmcnt(4)
    v_mfma_f32_32x32x16_bf16 v[96:111], a[176:179], v[36:39], v[96:111]
    buffer_load_dwordx4 v16, s[32:35], s60 offen sc1 lds
    s_add_u32 s61, s61, 4096
    v_mfma_f32_32x32x16_bf16 v[112:127], a[180:183], v[36:39], v[112:127]
    s_add_u32 s60, s60, 131072
    s_waitcnt vmcnt(22) lgkmcnt(2)
    v_mfma_f32_32x32x16_bf16 v[64:79], a[184:187], v[40:43], v[64:79]
    s_mov_b32 m0, s61
    s_waitcnt vmcnt(21)
    v_mfma_f32_32x32x16_bf16 v[80:95], a[188:191], v[40:43], v[80:95]
    buffer_load_dwordx4 v16, s[32:35], s60 offen sc1 lds
    s_waitcnt lgkmcnt(0)
    v_mfma_f32_32x32x16_bf16 v[96:111], a[184:187], v[44:47], v[96:111]
    v_mfma_f32_32x32x16_bf16 v[112:127], a[188:191], v[44:47], v[112:127]
    s_barrier
    s_lshl_b32 s53, s72, 6
    s_add_u32 s53, s53, 17674240
    v_mov_b32 v17, 17676288
    v_mov_b32 v18, 112
    v_writelane_b32 v17, s53, 0
    v_writelane_b32 v18, 1, 0
    s_mov_b32 exec_lo, 0x3
    s_mov_b32 exec_hi, 0
    global_load_dword v19, v17, s[30:31] sc1
    s_mov_b64 exec, -1
    ds_read_b64_tr_b16 v[24:25], v8 offset:49152
    ds_read_b64_tr_b16 v[26:27], v8 offset:49664
    ds_read_b64_tr_b16 v[28:29], v9 offset:49152
    ds_read_b64_tr_b16 v[30:31], v9 offset:49664
    ds_read_b64_tr_b16 v[32:33], v8 offset:51200
    ds_read_b64_tr_b16 v[34:35], v8 offset:51712
    ds_read_b64_tr_b16 v[36:37], v9 offset:51200
    ds_read_b64_tr_b16 v[38:39], v9 offset:51712
    s_waitcnt vmcnt(22) lgkmcnt(6)
    v_mfma_f32_32x32x16_bf16 v[64:79], a[192:195], v[24:27], v[64:79]
    ds_read_b64_tr_b16 v[40:41], v8 offset:53248
    s_waitcnt vmcnt(21)
    v_mfma_f32_32x32x16_bf16 v[80:95], a[196:199], v[24:27], v[80:95]
    buffer_load_dwordx4 a[224:227], v2, s[32:35], s62 offen offset:0 sc1
    ds_read_b64_tr_b16 v[42:43], v8 offset:53760
    s_waitcnt lgkmcnt(6)
    v_mfma_f32_32x32x16_bf16 v[96:111], a[192:195], v[28:31], v[96:111]
    buffer_load_dwordx4 a[228:231], v2, s[32:35], s62 offen offset:1024 sc1
    ds_read_b64_tr_b16 v[44:45], v9 offset:53248
    v_mfma_f32_32x32x16_bf16 v[112:127], a[196:199], v[28:31], v[112:127]
    ds_read_b64_tr_b16 v[46:47], v9 offset:53760
    s_waitcnt vmcnt(22) lgkmcnt(6)
    v_mfma_f32_32x32x16_bf16 v[64:79], a[200:203], v[32:35], v[64:79]
    buffer_load_dwordx4 a[232:235], v2, s[32:35], s62 offen offset:2048 sc1
    ds_read_b64_tr_b16 v[24:25], v8 offset:55296
    s_waitcnt vmcnt(22)
    v_mfma_f32_32x32x16_bf16 v[80:95], a[204:207], v[32:35], v[80:95]
    buffer_load_dwordx4 a[236:239], v2, s[32:35], s62 offen offset:3072 sc1
    ds_read_b64_tr_b16 v[26:27], v8 offset:55808
    s_waitcnt lgkmcnt(6)
    v_mfma_f32_32x32x16_bf16 v[96:111], a[200:203], v[36:39], v[96:111]
    ds_read_b64_tr_b16 v[28:29], v9 offset:55296
    v_mfma_f32_32x32x16_bf16 v[112:127], a[204:207], v[36:39], v[112:127]
    s_add_u32 s62, s62, 4096
    ds_read_b64_tr_b16 v[30:31], v9 offset:55808
    s_waitcnt vmcnt(22) lgkmcnt(6)
    v_mfma_f32_32x32x16_bf16 v[64:79], a[208:211], v[40:43], v[64:79]
    buffer_load_dwordx4 a[240:243], v2, s[32:35], s62 offen offset:0 sc1
    s_waitcnt vmcnt(22)
    v_mfma_f32_32x32x16_bf16 v[80:95], a[212:215], v[40:43], v[80:95]
    s_waitcnt lgkmcnt(4)
    v_mfma_f32_32x32x16_bf16 v[96:111], a[208:211], v[44:47], v[96:111]
    buffer_load_dwordx4 a[244:247], v2, s[32:35], s62 offen offset:1024 sc1
    v_mfma_f32_32x32x16_bf16 v[112:127], a[212:215], v[44:47], v[112:127]
    buffer_load_dwordx4 a[248:251], v2, s[32:35], s62 offen offset:2048 sc1
    s_waitcnt vmcnt(23) lgkmcnt(2)
    v_mfma_f32_32x32x16_bf16 v[64:79], a[216:219], v[24:27], v[64:79]
    buffer_load_dwordx4 a[252:255], v2, s[32:35], s62 offen offset:3072 sc1
    s_waitcnt vmcnt(23)
    v_mfma_f32_32x32x16_bf16 v[80:95], a[220:223], v[24:27], v[80:95]
    s_waitcnt lgkmcnt(0)
    v_mfma_f32_32x32x16_bf16 v[96:111], a[216:219], v[28:31], v[96:111]
    s_add_u32 s62, s62, 4096
    v_mfma_f32_32x32x16_bf16 v[112:127], a[220:223], v[28:31], v[112:127]
    s_mov_b32 exec_lo, 0x3
    s_mov_b32 exec_hi, 0
    s_waitcnt vmcnt(8)
    v_cmp_gt_u32 vcc, v18, v19
    s_mov_b64 exec, -1
    s_nop 3
    s_cmp_eq_u64 vcc, 0
    s_cbranch_scc1 sequential_preLN__ssm_conv_s4d__glu_gated_swiglu__prompt_kernel_cok36
    s_mov_b32 exec_lo, 0x3
    s_mov_b32 exec_hi, 0
    s_mov_b32 s52, 0
sequential_preLN__ssm_conv_s4d__glu_gated_swiglu__prompt_kernel_clp37:
    global_load_dword v19, v17, s[30:31] sc1
    s_add_u32 s52, s52, 1
    s_waitcnt vmcnt(0) lgkmcnt(0)
    v_cmp_gt_u32 vcc, v18, v19
    s_cmp_ge_u32 s52, 400000
    s_nop 3
    s_cbranch_scc1 sequential_preLN__ssm_conv_s4d__glu_gated_swiglu__prompt_kernel_cex38
    s_nop 3
    s_cmp_eq_u64 vcc, 0
    s_cbranch_scc0 sequential_preLN__ssm_conv_s4d__glu_gated_swiglu__prompt_kernel_clp37
sequential_preLN__ssm_conv_s4d__glu_gated_swiglu__prompt_kernel_cex38:
    s_mov_b64 exec, -1
sequential_preLN__ssm_conv_s4d__glu_gated_swiglu__prompt_kernel_cok36:
    v_and_b32 v4, 31, v1
    v_lshlrev_b32 v4, 3, v4
    s_lshl_b32 s54, s72, 9
    s_add_u32 s54, s54, 17678336
    buffer_load_dwordx2 v[224:225], v4, s[32:35], s54 offen offset:0 sc1
    buffer_load_dwordx2 v[228:229], v4, s[32:35], s54 offen offset:256 sc1
    s_lshl_b32 s54, s74, 11
    s_add_u32 s54, s54, 17694720
    buffer_load_dwordx4 v[192:195], v2, s[32:35], s54 offen offset:0 sc1
    buffer_load_dwordx4 v[196:199], v2, s[32:35], s54 offen offset:1024 sc1
    s_mov_b32 s56, -1
    s_mov_b32 s57, 0
    s_barrier
    ds_read_b64_tr_b16 v[24:25], v10 offset:0
    ds_read_b64_tr_b16 v[26:27], v10 offset:512
    ds_read_b64_tr_b16 v[28:29], v11 offset:0
    ds_read_b64_tr_b16 v[30:31], v11 offset:512
    ds_read_b64_tr_b16 v[32:33], v10 offset:2048
    ds_read_b64_tr_b16 v[34:35], v10 offset:2560
    ds_read_b64_tr_b16 v[36:37], v11 offset:2048
    ds_read_b64_tr_b16 v[38:39], v11 offset:2560
    s_waitcnt lgkmcnt(6)
    v_mfma_f32_32x32x16_bf16 v[128:143], a[0:3], v[24:27], 0
    ds_read_b64_tr_b16 v[40:41], v10 offset:4096
    v_mfma_f32_32x32x16_bf16 v[144:159], a[4:7], v[24:27], 0
    ds_read_b64_tr_b16 v[42:43], v10 offset:4608
    s_waitcnt lgkmcnt(6)
    v_mfma_f32_32x32x16_bf16 v[160:175], a[0:3], v[28:31], 0
    ds_read_b64_tr_b16 v[44:45], v11 offset:4096
    v_mfma_f32_32x32x16_bf16 v[176:191], a[4:7], v[28:31], 0
    ds_read_b64_tr_b16 v[46:47], v11 offset:4608
    s_waitcnt lgkmcnt(6)
    v_mfma_f32_32x32x16_bf16 v[128:143], a[8:11], v[32:35], v[128:143]
    ds_read_b64_tr_b16 v[24:25], v10 offset:6144
    v_mfma_f32_32x32x16_bf16 v[144:159], a[12:15], v[32:35], v[144:159]
    ds_read_b64_tr_b16 v[26:27], v10 offset:6656
    s_waitcnt lgkmcnt(6)
    v_mfma_f32_32x32x16_bf16 v[160:175], a[8:11], v[36:39], v[160:175]
    ds_read_b64_tr_b16 v[28:29], v11 offset:6144
    v_mfma_f32_32x32x16_bf16 v[176:191], a[12:15], v[36:39], v[176:191]
    ds_read_b64_tr_b16 v[30:31], v11 offset:6656
    buffer_load_dwordx4 a[0:3], v2, s[32:35], s62 offen offset:0 sc1
    buffer_load_dwordx4 a[4:7], v2, s[32:35], s62 offen offset:1024 sc1
    s_waitcnt lgkmcnt(6)
    v_mfma_f32_32x32x16_bf16 v[128:143], a[16:19], v[40:43], v[128:143]
    ds_read_b64_tr_b16 v[32:33], v10 offset:8192
    v_mfma_f32_32x32x16_bf16 v[144:159], a[20:23], v[40:43], v[144:159]
    ds_read_b64_tr_b16 v[34:35], v10 offset:8704
    s_waitcnt lgkmcnt(6)
    v_mfma_f32_32x32x16_bf16 v[160:175], a[16:19], v[44:47], v[160:175]
    ds_read_b64_tr_b16 v[36:37], v11 offset:8192
    v_mfma_f32_32x32x16_bf16 v[176:191], a[20:23], v[44:47], v[176:191]
    ds_read_b64_tr_b16 v[38:39], v11 offset:8704
    buffer_load_dwordx4 a[8:11], v2, s[32:35], s62 offen offset:2048 sc1
    buffer_load_dwordx4 a[12:15], v2, s[32:35], s62 offen offset:3072 sc1
    s_add_u32 s62, s62, 4096
    s_waitcnt lgkmcnt(6)
    v_mfma_f32_32x32x16_bf16 v[128:143], a[24:27], v[24:27], v[128:143]
    ds_read_b64_tr_b16 v[40:41], v10 offset:10240
    v_mfma_f32_32x32x16_bf16 v[144:159], a[28:31], v[24:27], v[144:159]
    ds_read_b64_tr_b16 v[42:43], v10 offset:10752
    s_waitcnt lgkmcnt(6)
    v_mfma_f32_32x32x16_bf16 v[160:175], a[24:27], v[28:31], v[160:175]
    s_waitcnt vmcnt(7)
    v_xor_b32 v200, 0x80000000, v224
    v_lshrrev_b32 v201, 16, v200
    v_or_b32_e64 v200, v200, v201
    ds_read_b64_tr_b16 v[44:45], v11 offset:10240
    v_mfma_f32_32x32x16_bf16 v[176:191], a[28:31], v[28:31], v[176:191]
    v_cndmask_b32 v200, 0, v200, s[56:57]
    v_mov_b32 v201, 0
    v_mov_b32 v202, 0
    ds_read_b64_tr_b16 v[46:47], v11 offset:10752
    buffer_load_dwordx4 a[16:19], v2, s[32:35], s62 offen offset:0 sc1
    buffer_load_dwordx4 a[20:23], v2, s[32:35], s62 offen offset:1024 sc1
    s_waitcnt lgkmcnt(6)
    v_mfma_f32_32x32x16_bf16 v[128:143], a[32:35], v[32:35], v[128:143]
    v_mov_b32 v203, 0
    v_mul_f32 v226, v225, v225
    v_rcp_f32 v227, v225
    ds_read_b64_tr_b16 v[24:25], v10 offset:12288
    v_mfma_f32_32x32x16_bf16 v[144:159], a[36:39], v[32:35], v[144:159]
    v_mul_f32 v227, 0xbfb8aa3b, v227
    s_waitcnt vmcnt(8)
    v_xor_b32 v204, 0x80000000, v228
    v_lshrrev_b32 v205, 16, v204
    ds_read_b64_tr_b16 v[26:27], v10 offset:12800
    s_waitcnt lgkmcnt(6)
    v_mfma_f32_32x32x16_bf16 v[160:175], a[32:35], v[36:39], v[160:175]
    v_or_b32 v204, v204, v205
    v_cndmask_b32 v204, 0, v204, s[56:57]
    v_mov_b32_e64 v205, 0
    ds_read_b64_tr_b16 v[28:29], v11 offset:12288
    v_mfma_f32_32x32x16_bf16 v[176:191], a[36:39], v[36:39], v[176:191]
    v_mov_b32 v206, 0
    v_mov_b32 v207, 0
    v_mul_f32_e64 v230, v229, v229
    ds_read_b64_tr_b16 v[30:31], v11 offset:12800
    buffer_load_dwordx4 a[24:27], v2, s[32:35], s62 offen offset:2048 sc1
    buffer_load_dwordx4 a[28:31], v2, s[32:35], s62 offen offset:3072 sc1
    s_add_u32 s62, s62, 4096
    s_waitcnt lgkmcnt(6)
    v_mfma_f32_32x32x16_bf16 v[128:143], a[40:43], v[40:43], v[128:143]
    v_rcp_f32 v231, v229
    s_nop 0
    v_mul_f32 v231, 0xbfb8aa3b, v231
    ds_read_b64_tr_b16 v[32:33], v10 offset:14336
    v_mfma_f32_32x32x16_bf16 v[144:159], a[44:47], v[40:43], v[144:159]
    ds_read_b64_tr_b16 v[34:35], v10 offset:14848
    s_waitcnt vmcnt(9)
    v_mfma_f32_32x32x16_bf16 v[64:79], v[192:195], v[200:203], v[64:79]
    s_waitcnt vmcnt(8)
    v_mfma_f32_32x32x16_bf16 v[80:95], v[196:199], v[200:203], v[80:95]
    v_mfma_f32_32x32x16_bf16 v[96:111], v[192:195], v[204:207], v[96:111]
    v_mfma_f32_32x32x16_bf16 v[112:127], v[196:199], v[204:207], v[112:127]
    s_lshl_b32 s53, s72, 6
    s_add_u32 s53, s53, 17675264
    v_mov_b32 v17, s53
    v_mov_b32 v18, 1
    s_mov_b32 exec_lo, 0x1
    s_mov_b32 exec_hi, 0
    global_load_dword v19, v17, s[30:31] sc1
    s_mov_b64 exec, -1
    s_waitcnt lgkmcnt(6)
    v_mfma_f32_32x32x16_bf16 v[160:175], a[40:43], v[44:47], v[160:175]
    ds_read_b64_tr_b16 v[36:37], v11 offset:14336
    v_mfma_f32_32x32x16_bf16 v[176:191], a[44:47], v[44:47], v[176:191]
    ds_read_b64_tr_b16 v[38:39], v11 offset:14848
    buffer_load_dwordx4 a[32:35], v2, s[32:35], s62 offen offset:0 sc1
    buffer_load_dwordx4 a[36:39], v2, s[32:35], s62 offen offset:1024 sc1
    s_waitcnt lgkmcnt(6)
    v_mfma_f32_32x32x16_bf16 v[128:143], a[48:51], v[24:27], v[128:143]
    s_add_u32 s65, s64, 0
    v_mul_f32 v240, v64, v227
    v_mul_f32 v241, v65, v227
    ds_read_b64_tr_b16 v[40:41], v10 offset:16384
    v_mfma_f32_32x32x16_bf16 v[144:159], a[52:55], v[24:27], v[144:159]
    v_mul_f32 v242, v64, v80
    v_mul_f32 v243, v65, v81
    v_exp_f32_e64 v240, v240
    ds_read_b64_tr_b16 v[42:43], v10 offset:16896
    s_waitcnt lgkmcnt(6)
    v_mfma_f32_32x32x16_bf16 v[160:175], a[48:51], v[28:31], v[160:175]
    v_exp_f32 v241, v241
    v_fma_f32 v240, v240, v226, v226
    v_fma_f32 v241, v241, v226, v226
    ds_read_b64_tr_b16 v[44:45], v11 offset:16384
    v_mfma_f32_32x32x16_bf16 v[176:191], a[52:55], v[28:31], v[176:191]
    v_rcp_f32 v240, v240
    v_rcp_f32 v241, v241
    v_mul_f32_e64 v242, v242, v240
    ds_read_b64_tr_b16 v[46:47], v11 offset:16896
    buffer_load_dwordx4 a[40:43], v2, s[32:35], s62 offen offset:2048 sc1
    buffer_load_dwordx4 a[44:47], v2, s[32:35], s62 offen offset:3072 sc1
    s_add_u32 s62, s62, 4096
    s_waitcnt lgkmcnt(6)
    v_mfma_f32_32x32x16_bf16 v[128:143], a[56:59], v[32:35], v[128:143]
    v_mul_f32 v243, v243, v241
    v_cvt_pk_bf16_f32 v48, v242, v243
    v_mul_f32 v244, v66, v227
    v_mul_f32 v245, v67, v227
    ds_read_b64_tr_b16 v[24:25], v10 offset:18432
    v_mfma_f32_32x32x16_bf16 v[144:159], a[60:63], v[32:35], v[144:159]
    v_mul_f32 v246, v66, v82
    v_mul_f32 v247, v67, v83
    v_exp_f32_e64 v244, v244
    ds_read_b64_tr_b16 v[26:27], v10 offset:18944
    s_waitcnt lgkmcnt(6)
    v_mfma_f32_32x32x16_bf16 v[160:175], a[56:59], v[36:39], v[160:175]
    v_exp_f32 v245, v245
    v_fma_f32 v244, v244, v226, v226
    v_fma_f32 v245, v245, v226, v226
    ds_read_b64_tr_b16 v[28:29], v11 offset:18432
    v_mfma_f32_32x32x16_bf16 v[176:191], a[60:63], v[36:39], v[176:191]
    v_rcp_f32 v244, v244
    v_rcp_f32 v245, v245
    v_mul_f32_e64 v246, v246, v244
    ds_read_b64_tr_b16 v[30:31], v11 offset:18944
    buffer_load_dwordx4 a[48:51], v2, s[32:35], s62 offen offset:0 sc1
    buffer_load_dwordx4 a[52:55], v2, s[32:35], s62 offen offset:1024 sc1
    s_waitcnt lgkmcnt(6)
    v_mfma_f32_32x32x16_bf16 v[128:143], a[64:67], v[40:43], v[128:143]
    v_mul_f32 v247, v247, v245
    v_cvt_pk_bf16_f32 v49, v246, v247
    v_mul_f32 v248, v68, v227
    v_mul_f32 v249, v69, v227
    ds_read_b64_tr_b16 v[32:33], v10 offset:20480
    v_mfma_f32_32x32x16_bf16 v[144:159], a[68:71], v[40:43], v[144:159]
    v_mul_f32 v250, v68, v84
    v_mul_f32 v251, v69, v85
    v_exp_f32_e64 v248, v248
    ds_read_b64_tr_b16 v[34:35], v10 offset:20992
    s_waitcnt lgkmcnt(6)
    v_mfma_f32_32x32x16_bf16 v[160:175], a[64:67], v[44:47], v[160:175]
    v_exp_f32 v249, v249
    v_fma_f32 v248, v248, v226, v226
    v_fma_f32 v249, v249, v226, v226
    ds_read_b64_tr_b16 v[36:37], v11 offset:20480
    v_mfma_f32_32x32x16_bf16 v[176:191], a[68:71], v[44:47], v[176:191]
    v_rcp_f32 v248, v248
    v_rcp_f32 v249, v249
    v_mul_f32_e64 v250, v250, v248
    ds_read_b64_tr_b16 v[38:39], v11 offset:20992
    buffer_load_dwordx4 a[56:59], v2, s[32:35], s62 offen offset:2048 sc1
    buffer_load_dwordx4 a[60:63], v2, s[32:35], s62 offen offset:3072 sc1
    s_add_u32 s62, s62, 4096
    s_waitcnt lgkmcnt(6)
    v_mfma_f32_32x32x16_bf16 v[128:143], a[72:75], v[24:27], v[128:143]
    v_mul_f32 v251, v251, v249
    v_cvt_pk_bf16_f32 v50, v250, v251
    v_mul_f32 v252, v70, v227
    v_mul_f32 v253, v71, v227
    ds_read_b64_tr_b16 v[40:41], v10 offset:22528
    v_mfma_f32_32x32x16_bf16 v[144:159], a[76:79], v[24:27], v[144:159]
    v_mul_f32 v254, v70, v86
    v_mul_f32 v255, v71, v87
    v_exp_f32_e64 v252, v252
    ds_read_b64_tr_b16 v[42:43], v10 offset:23040
    s_waitcnt lgkmcnt(6)
    v_mfma_f32_32x32x16_bf16 v[160:175], a[72:75], v[28:31], v[160:175]
    v_exp_f32 v253, v253
    v_fma_f32 v252, v252, v226, v226
    v_fma_f32 v253, v253, v226, v226
    ds_read_b64_tr_b16 v[44:45], v11 offset:22528
    v_mfma_f32_32x32x16_bf16 v[176:191], a[76:79], v[28:31], v[176:191]
    v_rcp_f32 v252, v252
    v_rcp_f32 v253, v253
    v_mul_f32_e64 v254, v254, v252
    ds_read_b64_tr_b16 v[46:47], v11 offset:23040
    buffer_load_dwordx4 a[64:67], v2, s[32:35], s62 offen offset:0 sc1
    buffer_load_dwordx4 a[68:71], v2, s[32:35], s62 offen offset:1024 sc1
    s_waitcnt lgkmcnt(6)
    v_mfma_f32_32x32x16_bf16 v[128:143], a[80:83], v[32:35], v[128:143]
    v_mul_f32 v255, v255, v253
    v_cvt_pk_bf16_f32 v51, v254, v255
    buffer_store_dwordx4 v[48:51], v2, s[32:35], s65 offen sc1
    v_mul_f32_e64 v240, v72, v227
    ds_read_b64_tr_b16 v[24:25], v10 offset:24576
    v_mfma_f32_32x32x16_bf16 v[144:159], a[84:87], v[32:35], v[144:159]
    v_mul_f32 v241, v73, v227
    v_mul_f32 v242, v72, v88
    v_mul_f32_e64 v243, v73, v89
    ds_read_b64_tr_b16 v[26:27], v10 offset:25088
    s_waitcnt lgkmcnt(6)
    v_mfma_f32_32x32x16_bf16 v[160:175], a[80:83], v[36:39], v[160:175]
    v_exp_f32 v240, v240
    v_exp_f32_e64 v241, v241
    v_fma_f32 v240, v240, v226, v226
    ds_read_b64_tr_b16 v[28:29], v11 offset:24576
    v_mfma_f32_32x32x16_bf16 v[176:191], a[84:87], v[36:39], v[176:191]
    v_fma_f32 v241, v241, v226, v226
    v_rcp_f32 v240, v240
    v_rcp_f32 v241, v241
    ds_read_b64_tr_b16 v[30:31], v11 offset:25088
    buffer_load_dwordx4 a[72:75], v2, s[32:35], s62 offen offset:2048 sc1
    buffer_load_dwordx4 a[76:79], v2, s[32:35], s62 offen offset:3072 sc1
    s_add_u32 s62, s62, 4096
    s_waitcnt lgkmcnt(6)
    v_mfma_f32_32x32x16_bf16 v[128:143], a[88:91], v[40:43], v[128:143]
    v_mul_f32 v242, v242, v240
    v_mul_f32_e64 v243, v243, v241
    v_cvt_pk_bf16_f32 v52, v242, v243
    v_mul_f32_e64 v244, v74, v227
    ds_read_b64_tr_b16 v[32:33], v10 offset:26624
    v_mfma_f32_32x32x16_bf16 v[144:159], a[92:95], v[40:43], v[144:159]
    v_mul_f32 v245, v75, v227
    v_mul_f32 v246, v74, v90
    v_mul_f32_e64 v247, v75, v91
    ds_read_b64_tr_b16 v[34:35], v10 offset:27136
    s_waitcnt lgkmcnt(6)
    v_mfma_f32_32x32x16_bf16 v[160:175], a[88:91], v[44:47], v[160:175]
    v_exp_f32 v244, v244
    v_exp_f32_e64 v245, v245
    v_fma_f32 v244, v244, v226, v226
    ds_read_b64_tr_b16 v[36:37], v11 offset:26624
    v_mfma_f32_32x32x16_bf16 v[176:191], a[92:95], v[44:47], v[176:191]
    v_fma_f32 v245, v245, v226, v226
    v_rcp_f32 v244, v244
    v_rcp_f32 v245, v245
    ds_read_b64_tr_b16 v[38:39], v11 offset:27136
    buffer_load_dwordx4 a[80:83], v2, s[32:35], s62 offen offset:0 sc1
    buffer_load_dwordx4 a[84:87], v2, s[32:35], s62 offen offset:1024 sc1
    s_waitcnt lgkmcnt(6)
    v_mfma_f32_32x32x16_bf16 v[128:143], a[96:99], v[24:27], v[128:143]
    v_mul_f32 v246, v246, v244
    v_mul_f32_e64 v247, v247, v245
    v_cvt_pk_bf16_f32 v53, v246, v247
    v_mul_f32_e64 v248, v76, v227
    ds_read_b64_tr_b16 v[40:41], v10 offset:28672
    v_mfma_f32_32x32x16_bf16 v[144:159], a[100:103], v[24:27], v[144:159]
    v_mul_f32 v249, v77, v227
    v_mul_f32 v250, v76, v92
    v_mul_f32_e64 v251, v77, v93
    ds_read_b64_tr_b16 v[42:43], v10 offset:29184
    s_waitcnt lgkmcnt(6)
    v_mfma_f32_32x32x16_bf16 v[160:175], a[96:99], v[28:31], v[160:175]
    v_exp_f32 v248, v248
    v_exp_f32_e64 v249, v249
    v_fma_f32 v248, v248, v226, v226
    ds_read_b64_tr_b16 v[44:45], v11 offset:28672
    v_mfma_f32_32x32x16_bf16 v[176:191], a[100:103], v[28:31], v[176:191]
    v_fma_f32 v249, v249, v226, v226
    v_rcp_f32 v248, v248
    v_rcp_f32 v249, v249
    ds_read_b64_tr_b16 v[46:47], v11 offset:29184
    buffer_load_dwordx4 a[88:91], v2, s[32:35], s62 offen offset:2048 sc1
    buffer_load_dwordx4 a[92:95], v2, s[32:35], s62 offen offset:3072 sc1
    s_add_u32 s62, s62, 4096
    s_waitcnt lgkmcnt(6)
    v_mfma_f32_32x32x16_bf16 v[128:143], a[104:107], v[32:35], v[128:143]
    v_mul_f32 v250, v250, v248
    v_mul_f32_e64 v251, v251, v249
    v_cvt_pk_bf16_f32 v54, v250, v251
    v_mul_f32_e64 v252, v78, v227
    ds_read_b64_tr_b16 v[24:25], v10 offset:30720
    v_mfma_f32_32x32x16_bf16 v[144:159], a[108:111], v[32:35], v[144:159]
    v_mul_f32 v253, v79, v227
    v_mul_f32 v254, v78, v94
    v_mul_f32_e64 v255, v79, v95
    ds_read_b64_tr_b16 v[26:27], v10 offset:31232
    s_waitcnt lgkmcnt(6)
    v_mfma_f32_32x32x16_bf16 v[160:175], a[104:107], v[36:39], v[160:175]
    v_exp_f32 v252, v252
    v_exp_f32_e64 v253, v253
    v_fma_f32 v252, v252, v226, v226
    ds_read_b64_tr_b16 v[28:29], v11 offset:30720
    v_mfma_f32_32x32x16_bf16 v[176:191], a[108:111], v[36:39], v[176:191]
    v_fma_f32 v253, v253, v226, v226
    v_rcp_f32 v252, v252
    v_rcp_f32 v253, v253
    ds_read_b64_tr_b16 v[30:31], v11 offset:31232
    buffer_load_dwordx4 a[96:99], v2, s[32:35], s62 offen offset:0 sc1
    s_waitcnt lgkmcnt(6)
    v_mfma_f32_32x32x16_bf16 v[128:143], a[112:115], v[40:43], v[128:143]
    v_mul_f32 v254, v254, v252
    v_mul_f32_e64 v255, v255, v253
    v_cvt_pk_bf16_f32 v55, v254, v255
    ds_read_b64_tr_b16 v[32:33], v10 offset:32768
    v_mfma_f32_32x32x16_bf16 v[144:159], a[116:119], v[40:43], v[144:159]
    buffer_store_dwordx4 v[52:55], v2, s[32:35], s65 offen offset:1024 sc1
    s_add_u32 s66, s64, 114688
    v_mul_f32 v240, v96, v231
    v_mul_f32 v241, v97, v231
    ds_read_b64_tr_b16 v[34:35], v10 offset:33280
    s_waitcnt lgkmcnt(6)
    v_mfma_f32_32x32x16_bf16 v[160:175], a[112:115], v[44:47], v[160:175]
    v_mul_f32 v242, v96, v112
    v_mul_f32 v243, v97, v113
    v_exp_f32 v240, v240
    ds_read_b64_tr_b16 v[36:37], v11 offset:32768
    v_mfma_f32_32x32x16_bf16 v[176:191], a[116:119], v[44:47], v[176:191]
    v_exp_f32_e64 v241, v241
    v_fma_f32 v240, v240, v230, v230
    v_fma_f32 v241, v241, v230, v230
    ds_read_b64_tr_b16 v[38:39], v11 offset:33280
    buffer_load_dwordx4 a[100:103], v2, s[32:35], s62 offen offset:1024 sc1
    buffer_load_dwordx4 a[104:107], v2, s[32:35], s62 offen offset:2048 sc1
    s_waitcnt lgkmcnt(6)
    v_mfma_f32_32x32x16_bf16 v[128:143], a[120:123], v[24:27], v[128:143]
    v_rcp_f32 v240, v240
    v_rcp_f32 v241, v241
    v_mul_f32 v242, v242, v240
    ds_read_b64_tr_b16 v[40:41], v10 offset:34816
    v_mfma_f32_32x32x16_bf16 v[144:159], a[124:127], v[24:27], v[144:159]
    v_mul_f32_e64 v243, v243, v241
    v_cvt_pk_bf16_f32 v56, v242, v243
    v_mul_f32 v244, v98, v231
    v_mul_f32 v245, v99, v231
    ds_read_b64_tr_b16 v[42:43], v10 offset:35328
    s_waitcnt lgkmcnt(6)
    v_mfma_f32_32x32x16_bf16 v[160:175], a[120:123], v[28:31], v[160:175]
    v_mul_f32 v246, v98, v114
    v_mul_f32 v247, v99, v115
    v_exp_f32 v244, v244
    ds_read_b64_tr_b16 v[44:45], v11 offset:34816
    v_mfma_f32_32x32x16_bf16 v[176:191], a[124:127], v[28:31], v[176:191]
    v_exp_f32_e64 v245, v245
    v_fma_f32 v244, v244, v230, v230
    v_fma_f32 v245, v245, v230, v230
    ds_read_b64_tr_b16 v[46:47], v11 offset:35328
    buffer_load_dwordx4 a[108:111], v2, s[32:35], s62 offen offset:3072 sc1
    s_add_u32 s62, s62, 4096
    buffer_load_dwordx4 a[112:115], v2, s[32:35], s62 offen offset:0 sc1
    s_waitcnt lgkmcnt(6)
    v_mfma_f32_32x32x16_bf16 v[128:143], a[128:131], v[32:35], v[128:143]
    v_rcp_f32 v244, v244
    v_rcp_f32 v245, v245
    v_mul_f32 v246, v246, v244
    ds_read_b64_tr_b16 v[24:25], v10 offset:36864
    v_mfma_f32_32x32x16_bf16 v[144:159], a[132:135], v[32:35], v[144:159]
    v_mul_f32_e64 v247, v247, v245
    v_cvt_pk_bf16_f32 v57, v246, v247
    v_mul_f32 v248, v100, v231
    v_mul_f32 v249, v101, v231
    ds_read_b64_tr_b16 v[26:27], v10 offset:37376
    s_waitcnt lgkmcnt(6)
    v_mfma_f32_32x32x16_bf16 v[160:175], a[128:131], v[36:39], v[160:175]
    v_mul_f32 v250, v100, v116
    v_mul_f32 v251, v101, v117
    v_exp_f32 v248, v248
    ds_read_b64_tr_b16 v[28:29], v11 offset:36864
    v_mfma_f32_32x32x16_bf16 v[176:191], a[132:135], v[36:39], v[176:191]
    v_exp_f32_e64 v249, v249
    v_fma_f32 v248, v248, v230, v230
    v_fma_f32 v249, v249, v230, v230
    ds_read_b64_tr_b16 v[30:31], v11 offset:37376
    buffer_load_dwordx4 a[116:119], v2, s[32:35], s62 offen offset:1024 sc1
    buffer_load_dwordx4 a[120:123], v2, s[32:35], s62 offen offset:2048 sc1
    s_waitcnt lgkmcnt(6)
    v_mfma_f32_32x32x16_bf16 v[128:143], a[136:139], v[40:43], v[128:143]
    v_rcp_f32 v248, v248
    v_rcp_f32 v249, v249
    v_mul_f32 v250, v250, v248
    ds_read_b64_tr_b16 v[32:33], v10 offset:38912
    v_mfma_f32_32x32x16_bf16 v[144:159], a[140:143], v[40:43], v[144:159]
    v_mul_f32_e64 v251, v251, v249
    v_cvt_pk_bf16_f32 v58, v250, v251
    v_mul_f32 v252, v102, v231
    v_mul_f32 v253, v103, v231
    ds_read_b64_tr_b16 v[34:35], v10 offset:39424
    s_waitcnt lgkmcnt(6)
    v_mfma_f32_32x32x16_bf16 v[160:175], a[136:139], v[44:47], v[160:175]
    v_mul_f32 v254, v102, v118
    v_mul_f32 v255, v103, v119
    v_exp_f32 v252, v252
    ds_read_b64_tr_b16 v[36:37], v11 offset:38912
    v_mfma_f32_32x32x16_bf16 v[176:191], a[140:143], v[44:47], v[176:191]
    v_exp_f32_e64 v253, v253
    v_fma_f32 v252, v252, v230, v230
    v_fma_f32 v253, v253, v230, v230
    ds_read_b64_tr_b16 v[38:39], v11 offset:39424
    buffer_load_dwordx4 a[124:127], v2, s[32:35], s62 offen offset:3072 sc1
    s_add_u32 s62, s62, 4096
    s_waitcnt lgkmcnt(6)
    v_mfma_f32_32x32x16_bf16 v[128:143], a[144:147], v[24:27], v[128:143]
    v_rcp_f32 v252, v252
    v_rcp_f32 v253, v253
    v_mul_f32 v254, v254, v252
    ds_read_b64_tr_b16 v[40:41], v10 offset:40960
    v_mfma_f32_32x32x16_bf16 v[144:159], a[148:151], v[24:27], v[144:159]
    v_mul_f32_e64 v255, v255, v253
    v_cvt_pk_bf16_f32 v59, v254, v255
    buffer_store_dwordx4 v[56:59], v2, s[32:35], s66 offen sc1
    v_mul_f32_e64 v240, v104, v231
    ds_read_b64_tr_b16 v[42:43], v10 offset:41472
    s_waitcnt lgkmcnt(6)
    v_mfma_f32_32x32x16_bf16 v[160:175], a[144:147], v[28:31], v[160:175]
    v_mul_f32 v241, v105, v231
    v_mul_f32 v242, v104, v120
    v_mul_f32 v243, v105, v121
    ds_read_b64_tr_b16 v[44:45], v11 offset:40960
    v_mfma_f32_32x32x16_bf16 v[176:191], a[148:151], v[28:31], v[176:191]
    v_exp_f32 v240, v240
    v_exp_f32 v241, v241
    v_fma_f32 v240, v240, v230, v230
    ds_read_b64_tr_b16 v[46:47], v11 offset:41472
    buffer_load_dwordx4 a[128:131], v2, s[32:35], s62 offen offset:0 sc1
    buffer_load_dwordx4 a[132:135], v2, s[32:35], s62 offen offset:1024 sc1
    s_waitcnt lgkmcnt(6)
    v_mfma_f32_32x32x16_bf16 v[128:143], a[152:155], v[32:35], v[128:143]
    v_fma_f32 v241, v241, v230, v230
    v_rcp_f32 v240, v240
    v_rcp_f32_e64 v241, v241
    ds_read_b64_tr_b16 v[24:25], v10 offset:43008
    v_mfma_f32_32x32x16_bf16 v[144:159], a[156:159], v[32:35], v[144:159]
    v_mul_f32 v242, v242, v240
    v_mul_f32 v243, v243, v241
    v_cvt_pk_bf16_f32 v60, v242, v243
    v_mul_f32_e64 v244, v106, v231
    ds_read_b64_tr_b16 v[26:27], v10 offset:43520
    s_waitcnt lgkmcnt(6)
    v_mfma_f32_32x32x16_bf16 v[160:175], a[152:155], v[36:39], v[160:175]
    v_mul_f32 v245, v107, v231
    v_mul_f32 v246, v106, v122
    v_mul_f32 v247, v107, v123
    ds_read_b64_tr_b16 v[28:29], v11 offset:43008
    v_mfma_f32_32x32x16_bf16 v[176:191], a[156:159], v[36:39], v[176:191]
    v_exp_f32 v244, v244
    v_exp_f32 v245, v245
    v_fma_f32 v244, v244, v230, v230
    ds_read_b64_tr_b16 v[30:31], v11 offset:43520
    buffer_load_dwordx4 a[136:139], v2, s[32:35], s62 offen offset:2048 sc1
    buffer_load_dwordx4 a[140:143], v2, s[32:35], s62 offen offset:3072 sc1
    s_add_u32 s62, s62, 4096
    s_waitcnt lgkmcnt(6)
    v_mfma_f32_32x32x16_bf16 v[128:143], a[160:163], v[40:43], v[128:143]
    v_fma_f32 v245, v245, v230, v230
    v_rcp_f32 v244, v244
    v_rcp_f32_e64 v245, v245
    ds_read_b64_tr_b16 v[32:33], v10 offset:45056
    v_mfma_f32_32x32x16_bf16 v[144:159], a[164:167], v[40:43], v[144:159]
    v_mul_f32 v246, v246, v244
    v_mul_f32 v247, v247, v245
    v_cvt_pk_bf16_f32 v61, v246, v247
    v_mul_f32_e64 v248, v108, v231
    ds_read_b64_tr_b16 v[34:35], v10 offset:45568
    s_waitcnt lgkmcnt(6)
    v_mfma_f32_32x32x16_bf16 v[160:175], a[160:163], v[44:47], v[160:175]
    v_mul_f32 v249, v109, v231
    v_mul_f32 v250, v108, v124
    v_mul_f32 v251, v109, v125
    ds_read_b64_tr_b16 v[36:37], v11 offset:45056
    v_mfma_f32_32x32x16_bf16 v[176:191], a[164:167], v[44:47], v[176:191]
    v_exp_f32 v248, v248
    v_exp_f32 v249, v249
    v_fma_f32 v248, v248, v230, v230
    ds_read_b64_tr_b16 v[38:39], v11 offset:45568
    buffer_load_dwordx4 a[144:147], v2, s[32:35], s62 offen offset:0 sc1
    buffer_load_dwordx4 a[148:151], v2, s[32:35], s62 offen offset:1024 sc1
    s_waitcnt lgkmcnt(6)
    v_mfma_f32_32x32x16_bf16 v[128:143], a[168:171], v[24:27], v[128:143]
    v_fma_f32 v249, v249, v230, v230
    v_rcp_f32 v248, v248
    v_rcp_f32_e64 v249, v249
    ds_read_b64_tr_b16 v[40:41], v10 offset:47104
    v_mfma_f32_32x32x16_bf16 v[144:159], a[172:175], v[24:27], v[144:159]
    v_mul_f32 v250, v250, v248
    v_mul_f32 v251, v251, v249
    v_cvt_pk_bf16_f32 v62, v250, v251
    v_mul_f32_e64 v252, v110, v231
    ds_read_b64_tr_b16 v[42:43], v10 offset:47616
    s_waitcnt lgkmcnt(6)
    v_mfma_f32_32x32x16_bf16 v[160:175], a[168:171], v[28:31], v[160:175]
    v_mul_f32 v253, v111, v231
    v_mul_f32 v254, v110, v126
    v_mul_f32 v255, v111, v127
    ds_read_b64_tr_b16 v[44:45], v11 offset:47104
    v_mfma_f32_32x32x16_bf16 v[176:191], a[172:175], v[28:31], v[176:191]
    v_exp_f32 v252, v252
    v_exp_f32 v253, v253
    v_fma_f32 v252, v252, v230, v230
    ds_read_b64_tr_b16 v[46:47], v11 offset:47616
    buffer_load_dwordx4 a[152:155], v2, s[32:35], s62 offen offset:2048 sc1
    buffer_load_dwordx4 a[156:159], v2, s[32:35], s62 offen offset:3072 sc1
    s_add_u32 s62, s62, 4096
    s_waitcnt lgkmcnt(6)
    v_mfma_f32_32x32x16_bf16 v[128:143], a[176:179], v[32:35], v[128:143]
    v_fma_f32 v253, v253, v230, v230
    v_rcp_f32 v252, v252
    v_rcp_f32_e64 v253, v253
    ds_read_b64_tr_b16 v[24:25], v10 offset:49152
    v_mfma_f32_32x32x16_bf16 v[144:159], a[180:183], v[32:35], v[144:159]
    v_mul_f32 v254, v254, v252
    v_mul_f32 v255, v255, v253
    v_cvt_pk_bf16_f32 v63, v254, v255
    ds_read_b64_tr_b16 v[26:27], v10 offset:49664
    s_waitcnt lgkmcnt(6)
    v_mfma_f32_32x32x16_bf16 v[160:175], a[176:179], v[36:39], v[160:175]
    buffer_store_dwordx4 v[60:63], v2, s[32:35], s66 offen offset:1024 sc1
    ds_read_b64_tr_b16 v[28:29], v11 offset:49152
    v_mfma_f32_32x32x16_bf16 v[176:191], a[180:183], v[36:39], v[176:191]
    ds_read_b64_tr_b16 v[30:31], v11 offset:49664
    buffer_load_dwordx4 a[160:163], v2, s[32:35], s62 offen offset:0 sc1
    s_mov_b32 exec_lo, 0x1
    s_mov_b32 exec_hi, 0
    s_waitcnt vmcnt(37)
    v_cmp_gt_u32 vcc, v18, v19
    s_mov_b64 exec, -1
    s_waitcnt lgkmcnt(0)
    s_nop 3
    s_cmp_eq_u64 vcc, 0
    s_cbranch_scc1 sequential_preLN__ssm_conv_s4d__glu_gated_swiglu__prompt_kernel_cok39
    s_mov_b32 exec_lo, 0x1
    s_mov_b32 exec_hi, 0
    s_mov_b32 s52, 0
sequential_preLN__ssm_conv_s4d__glu_gated_swiglu__prompt_kernel_clp40:
    global_load_dword v19, v17, s[30:31] sc1
    s_add_u32 s52, s52, 1
    s_waitcnt vmcnt(0) lgkmcnt(0)
    v_cmp_gt_u32 vcc, v18, v19
    s_cmp_ge_u32 s52, 400000
    s_nop 3
    s_cbranch_scc1 sequential_preLN__ssm_conv_s4d__glu_gated_swiglu__prompt_kernel_cex41
    s_nop 3
    s_cmp_eq_u64 vcc, 0
    s_cbranch_scc0 sequential_preLN__ssm_conv_s4d__glu_gated_swiglu__prompt_kernel_clp40
sequential_preLN__ssm_conv_s4d__glu_gated_swiglu__prompt_kernel_cex41:
    s_mov_b64 exec, -1
sequential_preLN__ssm_conv_s4d__glu_gated_swiglu__prompt_kernel_cok39:
    s_mov_b32 s56, -1
    s_mov_b32 s57, 0
    v_and_b32 v4, 31, v1
    v_lshlrev_b32 v4, 3, v4
    s_lshl_b32 s54, s72, 9
    s_add_u32 s54, s54, 17686528
    buffer_load_dwordx2 v[232:233], v4, s[32:35], s54 offen offset:0 sc1
    buffer_load_dwordx2 v[236:237], v4, s[32:35], s54 offen offset:256 sc1
    v_mfma_f32_32x32x16_bf16 v[128:143], a[184:187], v[40:43], v[128:143]
    ds_read_b64_tr_b16 v[32:33], v10 offset:51200
    v_mfma_f32_32x32x16_bf16 v[144:159], a[188:191], v[40:43], v[144:159]
    ds_read_b64_tr_b16 v[34:35], v10 offset:51712
    v_mfma_f32_32x32x16_bf16 v[160:175], a[184:187], v[44:47], v[160:175]
    ds_read_b64_tr_b16 v[36:37], v11 offset:51200
    v_mfma_f32_32x32x16_bf16 v[176:191], a[188:191], v[44:47], v[176:191]
    ds_read_b64_tr_b16 v[38:39], v11 offset:51712
    buffer_load_dwordx4 a[164:167], v2, s[32:35], s62 offen offset:1024 sc1
    buffer_load_dwordx4 a[168:171], v2, s[32:35], s62 offen offset:2048 sc1
    v_mfma_f32_32x32x16_bf16 v[128:143], a[192:195], v[24:27], v[128:143]
    ds_read_b64_tr_b16 v[40:41], v10 offset:53248
    v_mfma_f32_32x32x16_bf16 v[144:159], a[196:199], v[24:27], v[144:159]
    ds_read_b64_tr_b16 v[42:43], v10 offset:53760
    v_mfma_f32_32x32x16_bf16 v[160:175], a[192:195], v[28:31], v[160:175]
    ds_read_b64_tr_b16 v[44:45], v11 offset:53248
    v_mfma_f32_32x32x16_bf16 v[176:191], a[196:199], v[28:31], v[176:191]
    ds_read_b64_tr_b16 v[46:47], v11 offset:53760
    buffer_load_dwordx4 a[172:175], v2, s[32:35], s62 offen offset:3072 sc1
    s_add_u32 s62, s62, 4096
    buffer_load_dwordx4 a[176:179], v2, s[32:35], s62 offen offset:0 sc1
    s_waitcnt lgkmcnt(6)
    v_mfma_f32_32x32x16_bf16 v[128:143], a[200:203], v[32:35], v[128:143]
    ds_read_b64_tr_b16 v[24:25], v10 offset:55296
    v_mfma_f32_32x32x16_bf16 v[144:159], a[204:207], v[32:35], v[144:159]
    ds_read_b64_tr_b16 v[26:27], v10 offset:55808
    s_waitcnt lgkmcnt(6)
    v_mfma_f32_32x32x16_bf16 v[160:175], a[200:203], v[36:39], v[160:175]
    ds_read_b64_tr_b16 v[28:29], v11 offset:55296
    v_mfma_f32_32x32x16_bf16 v[176:191], a[204:207], v[36:39], v[176:191]
    ds_read_b64_tr_b16 v[30:31], v11 offset:55808
    buffer_load_dwordx4 a[180:183], v2, s[32:35], s62 offen offset:1024 sc1
    buffer_load_dwordx4 a[184:187], v2, s[32:35], s62 offen offset:2048 sc1
    s_waitcnt vmcnt(9)
    s_barrier
    s_lshl_b32 s52, s72, 7
    s_add_u32 s52, s52, 17670144
    s_cmp_lg_u32 s3, 0
    s_cbranch_scc1 sequential_preLN__ssm_conv_s4d__glu_gated_swiglu__prompt_kernel_arr42
    v_mov_b32 v4, s52
    v_mov_b32 v5, 1
    s_mov_b64 exec, 1
    global_atomic_add v4, v5, s[30:31]
    s_mov_b64 exec, -1
sequential_preLN__ssm_conv_s4d__glu_gated_swiglu__prompt_kernel_arr42:
    s_waitcnt lgkmcnt(6)
    v_mfma_f32_32x32x16_bf16 v[128:143], a[208:211], v[40:43], v[128:143]
    s_waitcnt vmcnt(7)
    v_xor_b32 v208, 0x80000000, v232
    v_lshrrev_b32_e64 v209, 16, v208
    v_mfma_f32_32x32x16_bf16 v[144:159], a[212:215], v[40:43], v[144:159]
    v_or_b32_e64 v208, v208, v209
    v_cndmask_b32 v208, 0, v208, s[56:57]
    s_waitcnt lgkmcnt(4)
    v_mfma_f32_32x32x16_bf16 v[160:175], a[208:211], v[44:47], v[160:175]
    v_mov_b32 v209, 0
    v_mov_b32_e64 v210, 0
    v_mfma_f32_32x32x16_bf16 v[176:191], a[212:215], v[44:47], v[176:191]
    v_mov_b32 v211, 0
    v_mul_f32 v234, v233, v233
    buffer_load_dwordx4 a[188:191], v2, s[32:35], s62 offen offset:3072 sc1
    s_add_u32 s62, s62, 4096
    s_waitcnt lgkmcnt(2)
    v_mfma_f32_32x32x16_bf16 v[128:143], a[216:219], v[24:27], v[128:143]
    v_rcp_f32 v235, v233
    s_nop 0
    v_mul_f32 v235, 0xbfb8aa3b, v235
    v_mfma_f32_32x32x16_bf16 v[144:159], a[220:223], v[24:27], v[144:159]
    s_waitcnt vmcnt(7)
    v_xor_b32 v212, 0x80000000, v236
    v_lshrrev_b32 v213, 16, v212
    s_waitcnt lgkmcnt(0)
    v_mfma_f32_32x32x16_bf16 v[160:175], a[216:219], v[28:31], v[160:175]
    v_or_b32_e64 v212, v212, v213
    v_cndmask_b32 v212, 0, v212, s[56:57]
    v_mfma_f32_32x32x16_bf16 v[176:191], a[220:223], v[28:31], v[176:191]
    v_mov_b32 v213, 0
    v_mov_b32 v214, 0
    v_mov_b32 v215, 0
    v_mul_f32 v238, v237, v237
    v_rcp_f32 v239, v237
    s_nop 0
    v_mul_f32 v239, 0xbfb8aa3b, v239
    v_mfma_f32_32x32x16_bf16 v[128:143], v[192:195], v[208:211], v[128:143]
    v_mfma_f32_32x32x16_bf16 v[144:159], v[196:199], v[208:211], v[144:159]
    v_mfma_f32_32x32x16_bf16 v[160:175], v[192:195], v[212:215], v[160:175]
    v_mfma_f32_32x32x16_bf16 v[176:191], v[196:199], v[212:215], v[176:191]
    s_add_u32 s65, s64, 3670016
    s_nop 7
    v_pk_mul_f32 v[240:241], v[128:129], v[234:235] op_sel:[0,1] op_sel_hi:[1,1]
    v_pk_mul_f32 v[242:243], v[128:129], v[144:145]
    v_exp_f32 v240, v240
    v_exp_f32 v241, v241
    s_nop 0
    v_pk_fma_f32 v[240:241], v[240:241], v[234:235], v[234:235] op_sel_hi:[1,0,0]
    v_rcp_f32 v240, v240
    v_rcp_f32 v241, v241
    s_nop 0
    v_pk_mul_f32 v[242:243], v[242:243], v[240:241]
    v_cvt_pk_bf16_f32 v48, v242, v243
    v_pk_mul_f32 v[244:245], v[130:131], v[234:235] op_sel:[0,1] op_sel_hi:[1,1]
    v_pk_mul_f32 v[246:247], v[130:131], v[146:147]
    v_exp_f32 v244, v244
    v_exp_f32 v245, v245
    s_nop 0
    v_pk_fma_f32 v[244:245], v[244:245], v[234:235], v[234:235] op_sel_hi:[1,0,0]
    v_rcp_f32 v244, v244
    v_rcp_f32 v245, v245
    s_nop 0
    v_pk_mul_f32 v[246:247], v[246:247], v[244:245]
    v_cvt_pk_bf16_f32 v49, v246, v247
    v_pk_mul_f32 v[248:249], v[132:133], v[234:235] op_sel:[0,1] op_sel_hi:[1,1]
    v_pk_mul_f32 v[250:251], v[132:133], v[148:149]
    v_exp_f32 v248, v248
    v_exp_f32 v249, v249
    s_nop 0
    v_pk_fma_f32 v[248:249], v[248:249], v[234:235], v[234:235] op_sel_hi:[1,0,0]
    v_rcp_f32 v248, v248
    v_rcp_f32 v249, v249
    s_nop 0
    v_pk_mul_f32 v[250:251], v[250:251], v[248:249]
    v_cvt_pk_bf16_f32 v50, v250, v251
    v_pk_mul_f32 v[252:253], v[134:135], v[234:235] op_sel:[0,1] op_sel_hi:[1,1]
    v_pk_mul_f32 v[254:255], v[134:135], v[150:151]
    v_exp_f32 v252, v252
    v_exp_f32 v253, v253
    s_nop 0
    v_pk_fma_f32 v[252:253], v[252:253], v[234:235], v[234:235] op_sel_hi:[1,0,0]
    v_rcp_f32 v252, v252
    v_rcp_f32 v253, v253
    s_nop 0
    v_pk_mul_f32 v[254:255], v[254:255], v[252:253]
    v_cvt_pk_bf16_f32 v51, v254, v255
    buffer_store_dwordx4 v[48:51], v2, s[32:35], s65 offen sc1
    v_pk_mul_f32 v[240:241], v[136:137], v[234:235] op_sel:[0,1] op_sel_hi:[1,1]
    v_pk_mul_f32 v[242:243], v[136:137], v[152:153]
    v_exp_f32 v240, v240
    v_exp_f32 v241, v241
    s_nop 0
    v_pk_fma_f32 v[240:241], v[240:241], v[234:235], v[234:235] op_sel_hi:[1,0,0]
    v_rcp_f32 v240, v240
    v_rcp_f32 v241, v241
    s_nop 0
    v_pk_mul_f32 v[242:243], v[242:243], v[240:241]
    v_cvt_pk_bf16_f32 v52, v242, v243
    v_pk_mul_f32 v[244:245], v[138:139], v[234:235] op_sel:[0,1] op_sel_hi:[1,1]
    v_pk_mul_f32 v[246:247], v[138:139], v[154:155]
    v_exp_f32 v244, v244
    v_exp_f32 v245, v245
    s_nop 0
    v_pk_fma_f32 v[244:245], v[244:245], v[234:235], v[234:235] op_sel_hi:[1,0,0]
    v_rcp_f32 v244, v244
    v_rcp_f32 v245, v245
    s_nop 0
    v_pk_mul_f32 v[246:247], v[246:247], v[244:245]
    v_cvt_pk_bf16_f32 v53, v246, v247
    v_pk_mul_f32 v[248:249], v[140:141], v[234:235] op_sel:[0,1] op_sel_hi:[1,1]
    v_pk_mul_f32 v[250:251], v[140:141], v[156:157]
    v_exp_f32 v248, v248
    v_exp_f32 v249, v249
    s_nop 0
    v_pk_fma_f32 v[248:249], v[248:249], v[234:235], v[234:235] op_sel_hi:[1,0,0]
    v_rcp_f32 v248, v248
    v_rcp_f32 v249, v249
    s_nop 0
    v_pk_mul_f32 v[250:251], v[250:251], v[248:249]
    v_cvt_pk_bf16_f32 v54, v250, v251
    v_pk_mul_f32 v[252:253], v[142:143], v[234:235] op_sel:[0,1] op_sel_hi:[1,1]
    v_pk_mul_f32 v[254:255], v[142:143], v[158:159]
    v_exp_f32 v252, v252
    v_exp_f32 v253, v253
    s_nop 0
    v_pk_fma_f32 v[252:253], v[252:253], v[234:235], v[234:235] op_sel_hi:[1,0,0]
    v_rcp_f32 v252, v252
    v_rcp_f32 v253, v253
    s_nop 0
    v_pk_mul_f32 v[254:255], v[254:255], v[252:253]
    v_cvt_pk_bf16_f32 v55, v254, v255
    buffer_store_dwordx4 v[52:55], v2, s[32:35], s65 offen offset:1024 sc1
    s_lshr_b32 s53, s75, 1
    s_lshl_b32 s53, s53, 7
    s_add_u32 s53, s53, 17670144
    v_mov_b32 v17, s53
    v_mov_b32 v18, 14
    s_mov_b32 exec_lo, 0x1
    s_mov_b32 exec_hi, 0
    global_load_dword v19, v17, s[30:31] sc1
    s_mov_b64 exec, -1
    s_add_u32 s66, s64, 3784704
    v_pk_mul_f32 v[240:241], v[160:161], v[238:239] op_sel:[0,1] op_sel_hi:[1,1]
    v_pk_mul_f32 v[242:243], v[160:161], v[176:177]
    v_exp_f32 v240, v240
    v_exp_f32 v241, v241
    s_nop 0
    v_pk_fma_f32 v[240:241], v[240:241], v[238:239], v[238:239] op_sel_hi:[1,0,0]
    v_rcp_f32 v240, v240
    v_rcp_f32 v241, v241
    s_nop 0
    v_pk_mul_f32 v[242:243], v[242:243], v[240:241]
    v_cvt_pk_bf16_f32 v56, v242, v243
    v_pk_mul_f32 v[244:245], v[162:163], v[238:239] op_sel:[0,1] op_sel_hi:[1,1]
    v_pk_mul_f32 v[246:247], v[162:163], v[178:179]
    v_exp_f32 v244, v244
    v_exp_f32 v245, v245
    s_nop 0
    v_pk_fma_f32 v[244:245], v[244:245], v[238:239], v[238:239] op_sel_hi:[1,0,0]
    v_rcp_f32 v244, v244
    v_rcp_f32 v245, v245
    s_nop 0
    v_pk_mul_f32 v[246:247], v[246:247], v[244:245]
    v_cvt_pk_bf16_f32 v57, v246, v247
    v_pk_mul_f32 v[248:249], v[164:165], v[238:239] op_sel:[0,1] op_sel_hi:[1,1]
    v_pk_mul_f32 v[250:251], v[164:165], v[180:181]
    v_exp_f32 v248, v248
    v_exp_f32 v249, v249
    s_nop 0
    v_pk_fma_f32 v[248:249], v[248:249], v[238:239], v[238:239] op_sel_hi:[1,0,0]
    v_rcp_f32 v248, v248
    v_rcp_f32 v249, v249
    s_nop 0
    v_pk_mul_f32 v[250:251], v[250:251], v[248:249]
    v_cvt_pk_bf16_f32 v58, v250, v251
    v_pk_mul_f32 v[252:253], v[166:167], v[238:239] op_sel:[0,1] op_sel_hi:[1,1]
    v_pk_mul_f32 v[254:255], v[166:167], v[182:183]
    v_exp_f32 v252, v252
    v_exp_f32 v253, v253
    s_nop 0
    v_pk_fma_f32 v[252:253], v[252:253], v[238:239], v[238:239] op_sel_hi:[1,0,0]
    v_rcp_f32 v252, v252
    v_rcp_f32 v253, v253
    s_nop 0
    v_pk_mul_f32 v[254:255], v[254:255], v[252:253]
    v_cvt_pk_bf16_f32 v59, v254, v255
    buffer_store_dwordx4 v[56:59], v2, s[32:35], s66 offen sc1
    v_pk_mul_f32 v[240:241], v[168:169], v[238:239] op_sel:[0,1] op_sel_hi:[1,1]
    v_pk_mul_f32 v[242:243], v[168:169], v[184:185]
    v_exp_f32 v240, v240
    v_exp_f32 v241, v241
    s_nop 0
    v_pk_fma_f32 v[240:241], v[240:241], v[238:239], v[238:239] op_sel_hi:[1,0,0]
    v_rcp_f32 v240, v240
    v_rcp_f32 v241, v241
    s_nop 0
    v_pk_mul_f32 v[242:243], v[242:243], v[240:241]
    v_cvt_pk_bf16_f32 v60, v242, v243
    v_pk_mul_f32 v[244:245], v[170:171], v[238:239] op_sel:[0,1] op_sel_hi:[1,1]
    v_pk_mul_f32 v[246:247], v[170:171], v[186:187]
    v_exp_f32 v244, v244
    v_exp_f32 v245, v245
    s_nop 0
    v_pk_fma_f32 v[244:245], v[244:245], v[238:239], v[238:239] op_sel_hi:[1,0,0]
    v_rcp_f32 v244, v244
    v_rcp_f32 v245, v245
    s_nop 0
    v_pk_mul_f32 v[246:247], v[246:247], v[244:245]
    v_cvt_pk_bf16_f32 v61, v246, v247
    v_pk_mul_f32 v[248:249], v[172:173], v[238:239] op_sel:[0,1] op_sel_hi:[1,1]
    v_pk_mul_f32 v[250:251], v[172:173], v[188:189]
    v_exp_f32 v248, v248
    v_exp_f32 v249, v249
    s_nop 0
    v_pk_fma_f32 v[248:249], v[248:249], v[238:239], v[238:239] op_sel_hi:[1,0,0]
    v_rcp_f32 v248, v248
    v_rcp_f32 v249, v249
    s_nop 0
    v_pk_mul_f32 v[250:251], v[250:251], v[248:249]
    v_cvt_pk_bf16_f32 v62, v250, v251
    v_pk_mul_f32 v[252:253], v[174:175], v[238:239] op_sel:[0,1] op_sel_hi:[1,1]
    v_pk_mul_f32 v[254:255], v[174:175], v[190:191]
    v_exp_f32 v252, v252
    v_exp_f32 v253, v253
    s_nop 0
    v_pk_fma_f32 v[252:253], v[252:253], v[238:239], v[238:239] op_sel_hi:[1,0,0]
    v_rcp_f32 v252, v252
    v_rcp_f32 v253, v253
    s_nop 0
    v_pk_mul_f32 v[254:255], v[254:255], v[252:253]
    v_cvt_pk_bf16_f32 v63, v254, v255
    buffer_store_dwordx4 v[60:63], v2, s[32:35], s66 offen offset:1024 sc1
    s_mov_b32 s36, s26
    s_mov_b32 s37, s27
    s_mov_b32 s38, 1835008
    s_mov_b32 s39, 0x20000
    s_mov_b32 exec_lo, 0x1
    s_mov_b32 exec_hi, 0
    s_waitcnt vmcnt(2)
    v_cmp_gt_u32 vcc, v18, v19
    s_mov_b64 exec, -1
    s_nop 3
    s_cmp_eq_u64 vcc, 0
    s_cbranch_scc1 sequential_preLN__ssm_conv_s4d__glu_gated_swiglu__prompt_kernel_cok43
    s_mov_b32 exec_lo, 0x1
    s_mov_b32 exec_hi, 0
    s_mov_b32 s52, 0
sequential_preLN__ssm_conv_s4d__glu_gated_swiglu__prompt_kernel_clp44:
    global_load_dword v19, v17, s[30:31] sc1
    s_add_u32 s52, s52, 1
    s_waitcnt vmcnt(0) lgkmcnt(0)
    v_cmp_gt_u32 vcc, v18, v19
    s_cmp_ge_u32 s52, 400000
    s_nop 3
    s_cbranch_scc1 sequential_preLN__ssm_conv_s4d__glu_gated_swiglu__prompt_kernel_cex45
    s_nop 3
    s_cmp_eq_u64 vcc, 0
    s_cbranch_scc0 sequential_preLN__ssm_conv_s4d__glu_gated_swiglu__prompt_kernel_clp44
sequential_preLN__ssm_conv_s4d__glu_gated_swiglu__prompt_kernel_cex45:
    s_mov_b64 exec, -1
sequential_preLN__ssm_conv_s4d__glu_gated_swiglu__prompt_kernel_cok43:
    s_mul_i32 s62, s3, 28
    s_mul_i32 s60, s75, 112
    s_add_u32 s60, s60, s62
    s_lshl_b32 s60, s60, 10
    s_add_u32 s60, s60, 10321920
    buffer_load_dwordx4 v[32:35], v2, s[32:35], s60 offen offset:0 sc1
    buffer_load_dwordx4 v[36:39], v2, s[32:35], s60 offen offset:1024 sc1
    buffer_load_dwordx4 v[40:43], v2, s[32:35], s60 offen offset:2048 sc1
    buffer_load_dwordx4 v[44:47], v2, s[32:35], s60 offen offset:3072 sc1
    s_add_u32 s60, s60, 4096
    buffer_load_dwordx4 v[48:51], v2, s[32:35], s60 offen offset:0 sc1
    buffer_load_dwordx4 v[52:55], v2, s[32:35], s60 offen offset:1024 sc1
    buffer_load_dwordx4 v[56:59], v2, s[32:35], s60 offen offset:2048 sc1
    buffer_load_dwordx4 v[60:63], v2, s[32:35], s60 offen offset:3072 sc1
    s_add_u32 s60, s60, 4096
    s_waitcnt vmcnt(8)
    s_barrier
    s_lshl_b32 s52, s72, 7
    s_add_u32 s52, s52, 17672192
    s_cmp_lg_u32 s3, 0
    s_cbranch_scc1 sequential_preLN__ssm_conv_s4d__glu_gated_swiglu__prompt_kernel_arr46
    v_mov_b32 v4, s52
    v_mov_b32 v5, 1
    s_mov_b64 exec, 1
    global_atomic_add v4, v5, s[30:31]
    s_mov_b64 exec, -1
sequential_preLN__ssm_conv_s4d__glu_gated_swiglu__prompt_kernel_arr46:
    buffer_load_dwordx4 v[64:67], v2, s[32:35], s60 offen offset:0 sc1
    buffer_load_dwordx4 v[68:71], v2, s[32:35], s60 offen offset:1024 sc1
    v_lshrrev_b32 v4, 2, v1
    v_lshlrev_b32 v4, 12, v4
    v_and_b32_e64 v5, 3, v1
    v_lshl_add_u32 v4, v5, 4, v4
    s_lshl_b32 s63, s76, 18
    s_lshr_b32 s64, s3, 1
    s_lshl_b32 s64, s64, 17
    s_add_u32 s63, s63, s64
    s_and_b32 s64, s3, 1
    s_lshl_b32 s64, s64, 11
    s_add_u32 s63, s63, s64
    s_lshl_b32 s64, s75, 6
    s_add_u32 s63, s63, s64
    s_add_u32 s63, s63, 3670016
    s_lshl_b32 s64, s3, 11
    s_add_u32 s64, s64, 65536
    s_mov_b32 m0, s64
    s_nop 0
    buffer_load_dwordx4 v4, s[32:35], s63 offen sc1 lds
    s_add_u32 s63, s63, 65536
    s_add_u32 s64, s64, 1024
    s_mov_b32 m0, s64
    s_nop 0
    buffer_load_dwordx4 v4, s[32:35], s63 offen sc1 lds
    s_waitcnt vmcnt(11)
    v_mfma_f32_32x32x16_bf16 v[192:207], a[224:227], v[32:35], 0
    v_mfma_f32_32x32x16_bf16 v[224:239], a[228:231], v[32:35], 0
    buffer_load_dwordx4 v[72:75], v2, s[32:35], s60 offen offset:2048 sc1
    s_waitcnt vmcnt(11)
    v_mfma_f32_32x32x16_bf16 v[192:207], a[232:235], v[36:39], v[192:207]
    v_mfma_f32_32x32x16_bf16 v[224:239], a[236:239], v[36:39], v[224:239]
    buffer_load_dwordx4 v[76:79], v2, s[32:35], s60 offen offset:3072 sc1
    s_add_u32 s60, s60, 4096
    s_waitcnt vmcnt(11)
    v_mfma_f32_32x32x16_bf16 v[192:207], a[240:243], v[40:43], v[192:207]
    v_mfma_f32_32x32x16_bf16 v[224:239], a[244:247], v[40:43], v[224:239]
    buffer_load_dwordx4 v[80:83], v2, s[32:35], s60 offen offset:0 sc1
    s_waitcnt vmcnt(11)
    v_mfma_f32_32x32x16_bf16 v[192:207], a[248:251], v[44:47], v[192:207]
    v_mfma_f32_32x32x16_bf16 v[224:239], a[252:255], v[44:47], v[224:239]
    buffer_load_dwordx4 v[84:87], v2, s[32:35], s60 offen offset:1024 sc1
    s_waitcnt vmcnt(11)
    v_mfma_f32_32x32x16_bf16 v[192:207], a[0:3], v[48:51], v[192:207]
    v_mfma_f32_32x32x16_bf16 v[224:239], a[4:7], v[48:51], v[224:239]
    buffer_load_dwordx4 v[88:91], v2, s[32:35], s60 offen offset:2048 sc1
    s_waitcnt vmcnt(11)
    v_mfma_f32_32x32x16_bf16 v[192:207], a[8:11], v[52:55], v[192:207]
    v_mfma_f32_32x32x16_bf16 v[224:239], a[12:15], v[52:55], v[224:239]
    buffer_load_dwordx4 v[92:95], v2, s[32:35], s60 offen offset:3072 sc1
    s_add_u32 s60, s60, 4096
    s_waitcnt vmcnt(11)
    v_mfma_f32_32x32x16_bf16 v[192:207], a[16:19], v[56:59], v[192:207]
    v_mfma_f32_32x32x16_bf16 v[224:239], a[20:23], v[56:59], v[224:239]
    buffer_load_dwordx4 v[96:99], v2, s[32:35], s60 offen offset:0 sc1
    s_waitcnt vmcnt(11)
    v_mfma_f32_32x32x16_bf16 v[192:207], a[24:27], v[60:63], v[192:207]
    v_mfma_f32_32x32x16_bf16 v[224:239], a[28:31], v[60:63], v[224:239]
    buffer_load_dwordx4 v[100:103], v2, s[32:35], s60 offen offset:1024 sc1
    s_lshr_b32 s53, s75, 1
    s_lshl_b32 s53, s53, 7
    s_add_u32 s53, s53, 17672192
    v_mov_b32 v17, s53
    v_mov_b32 v18, 14
    s_mov_b32 exec_lo, 0x1
    s_mov_b32 exec_hi, 0
    global_load_dword v19, v17, s[30:31] sc1
    s_mov_b64 exec, -1
    s_waitcnt vmcnt(12)
    v_mfma_f32_32x32x16_bf16 v[192:207], a[32:35], v[64:67], v[192:207]
    v_mfma_f32_32x32x16_bf16 v[224:239], a[36:39], v[64:67], v[224:239]
    buffer_load_dwordx4 v[104:107], v2, s[32:35], s60 offen offset:2048 sc1
    s_waitcnt vmcnt(12)
    v_mfma_f32_32x32x16_bf16 v[192:207], a[40:43], v[68:71], v[192:207]
    v_mfma_f32_32x32x16_bf16 v[224:239], a[44:47], v[68:71], v[224:239]
    buffer_load_dwordx4 v[108:111], v2, s[32:35], s60 offen offset:3072 sc1
    s_add_u32 s60, s60, 4096
    s_waitcnt vmcnt(10)
    v_mfma_f32_32x32x16_bf16 v[192:207], a[48:51], v[72:75], v[192:207]
    v_mfma_f32_32x32x16_bf16 v[224:239], a[52:55], v[72:75], v[224:239]
    buffer_load_dwordx4 v[112:115], v2, s[32:35], s60 offen offset:0 sc1
    s_waitcnt vmcnt(10)
    v_mfma_f32_32x32x16_bf16 v[192:207], a[56:59], v[76:79], v[192:207]
    v_mfma_f32_32x32x16_bf16 v[224:239], a[60:63], v[76:79], v[224:239]
    buffer_load_dwordx4 v[116:119], v2, s[32:35], s60 offen offset:1024 sc1
    s_waitcnt vmcnt(10)
    v_mfma_f32_32x32x16_bf16 v[192:207], a[64:67], v[80:83], v[192:207]
    v_mfma_f32_32x32x16_bf16 v[224:239], a[68:71], v[80:83], v[224:239]
    buffer_load_dwordx4 v[120:123], v2, s[32:35], s60 offen offset:2048 sc1
    s_waitcnt vmcnt(10)
    v_mfma_f32_32x32x16_bf16 v[192:207], a[72:75], v[84:87], v[192:207]
    v_mfma_f32_32x32x16_bf16 v[224:239], a[76:79], v[84:87], v[224:239]
    buffer_load_dwordx4 v[124:127], v2, s[32:35], s60 offen offset:3072 sc1
    s_add_u32 s60, s60, 4096
    s_waitcnt vmcnt(10)
    v_mfma_f32_32x32x16_bf16 v[192:207], a[80:83], v[88:91], v[192:207]
    v_mfma_f32_32x32x16_bf16 v[224:239], a[84:87], v[88:91], v[224:239]
    buffer_load_dwordx4 v[128:131], v2, s[32:35], s60 offen offset:0 sc1
    s_waitcnt vmcnt(10)
    v_mfma_f32_32x32x16_bf16 v[192:207], a[88:91], v[92:95], v[192:207]
    v_mfma_f32_32x32x16_bf16 v[224:239], a[92:95], v[92:95], v[224:239]
    buffer_load_dwordx4 v[132:135], v2, s[32:35], s60 offen offset:1024 sc1
    s_waitcnt vmcnt(10)
    v_mfma_f32_32x32x16_bf16 v[192:207], a[96:99], v[96:99], v[192:207]
    v_mfma_f32_32x32x16_bf16 v[224:239], a[100:103], v[96:99], v[224:239]
    buffer_load_dwordx4 v[136:139], v2, s[32:35], s60 offen offset:2048 sc1
    s_waitcnt vmcnt(10)
    v_mfma_f32_32x32x16_bf16 v[192:207], a[104:107], v[100:103], v[192:207]
    v_mfma_f32_32x32x16_bf16 v[224:239], a[108:111], v[100:103], v[224:239]
    buffer_load_dwordx4 v[140:143], v2, s[32:35], s60 offen offset:3072 sc1
    s_add_u32 s60, s60, 4096
    s_mov_b32 exec_lo, 0x1
    s_mov_b32 exec_hi, 0
    s_waitcnt vmcnt(10)
    v_cmp_gt_u32 vcc, v18, v19
    s_mov_b64 exec, -1
    s_nop 3
    s_cmp_eq_u64 vcc, 0
    s_cbranch_scc1 sequential_preLN__ssm_conv_s4d__glu_gated_swiglu__prompt_kernel_cok47
    s_mov_b32 exec_lo, 0x1
    s_mov_b32 exec_hi, 0
    s_mov_b32 s52, 0
sequential_preLN__ssm_conv_s4d__glu_gated_swiglu__prompt_kernel_clp48:
    global_load_dword v19, v17, s[30:31] sc1
    s_add_u32 s52, s52, 1
    s_waitcnt vmcnt(0) lgkmcnt(0)
    v_cmp_gt_u32 vcc, v18, v19
    s_cmp_ge_u32 s52, 400000
    s_nop 3
    s_cbranch_scc1 sequential_preLN__ssm_conv_s4d__glu_gated_swiglu__prompt_kernel_cex49
    s_nop 3
    s_cmp_eq_u64 vcc, 0
    s_cbranch_scc0 sequential_preLN__ssm_conv_s4d__glu_gated_swiglu__prompt_kernel_clp48
sequential_preLN__ssm_conv_s4d__glu_gated_swiglu__prompt_kernel_cex49:
    s_mov_b64 exec, -1
sequential_preLN__ssm_conv_s4d__glu_gated_swiglu__prompt_kernel_cok47:
    s_mul_i32 s62, s3, 28
    s_mul_i32 s60, s75, 112
    s_add_u32 s60, s60, s62
    s_lshl_b32 s60, s60, 10
    s_add_u32 s60, s60, 13991936
    s_waitcnt vmcnt(9)
    v_mfma_f32_32x32x16_bf16 v[192:207], a[112:115], v[104:107], v[192:207]
    v_mfma_f32_32x32x16_bf16 v[224:239], a[116:119], v[104:107], v[224:239]
    buffer_load_dwordx4 v[32:35], v2, s[32:35], s60 offen offset:0 sc1
    s_waitcnt vmcnt(9)
    v_mfma_f32_32x32x16_bf16 v[192:207], a[120:123], v[108:111], v[192:207]
    v_mfma_f32_32x32x16_bf16 v[224:239], a[124:127], v[108:111], v[224:239]
    buffer_load_dwordx4 v[36:39], v2, s[32:35], s60 offen offset:1024 sc1
    s_waitcnt vmcnt(9)
    v_mfma_f32_32x32x16_bf16 v[192:207], a[128:131], v[112:115], v[192:207]
    v_mfma_f32_32x32x16_bf16 v[224:239], a[132:135], v[112:115], v[224:239]
    buffer_load_dwordx4 v[40:43], v2, s[32:35], s60 offen offset:2048 sc1
    s_waitcnt vmcnt(9)
    v_mfma_f32_32x32x16_bf16 v[192:207], a[136:139], v[116:119], v[192:207]
    v_mfma_f32_32x32x16_bf16 v[224:239], a[140:143], v[116:119], v[224:239]
    buffer_load_dwordx4 v[44:47], v2, s[32:35], s60 offen offset:3072 sc1
    s_add_u32 s60, s60, 4096
    s_waitcnt vmcnt(9)
    v_mfma_f32_32x32x16_bf16 v[192:207], a[144:147], v[120:123], v[192:207]
    v_mfma_f32_32x32x16_bf16 v[224:239], a[148:151], v[120:123], v[224:239]
    buffer_load_dwordx4 v[48:51], v2, s[32:35], s60 offen offset:0 sc1
    s_waitcnt vmcnt(9)
    v_mfma_f32_32x32x16_bf16 v[192:207], a[152:155], v[124:127], v[192:207]
    v_mfma_f32_32x32x16_bf16 v[224:239], a[156:159], v[124:127], v[224:239]
    buffer_load_dwordx4 v[52:55], v2, s[32:35], s60 offen offset:1024 sc1
    s_waitcnt vmcnt(9)
    v_mfma_f32_32x32x16_bf16 v[192:207], a[160:163], v[128:131], v[192:207]
    v_mfma_f32_32x32x16_bf16 v[224:239], a[164:167], v[128:131], v[224:239]
    buffer_load_dwordx4 v[56:59], v2, s[32:35], s60 offen offset:2048 sc1
    s_waitcnt vmcnt(9)
    v_mfma_f32_32x32x16_bf16 v[192:207], a[168:171], v[132:135], v[192:207]
    v_mfma_f32_32x32x16_bf16 v[224:239], a[172:175], v[132:135], v[224:239]
    buffer_load_dwordx4 v[60:63], v2, s[32:35], s60 offen offset:3072 sc1
    s_add_u32 s60, s60, 4096
    s_waitcnt vmcnt(9)
    v_mfma_f32_32x32x16_bf16 v[192:207], a[176:179], v[136:139], v[192:207]
    v_mfma_f32_32x32x16_bf16 v[224:239], a[180:183], v[136:139], v[224:239]
    buffer_load_dwordx4 v[64:67], v2, s[32:35], s60 offen offset:0 sc1
    s_waitcnt vmcnt(9)
    v_mfma_f32_32x32x16_bf16 v[192:207], a[184:187], v[140:143], v[192:207]
    v_mfma_f32_32x32x16_bf16 v[224:239], a[188:191], v[140:143], v[224:239]
    buffer_load_dwordx4 v[68:71], v2, s[32:35], s60 offen offset:1024 sc1
    s_waitcnt vmcnt(9)
    v_mfma_f32_32x32x16_bf16 v[208:223], a[224:227], v[32:35], 0
    v_mfma_f32_32x32x16_bf16 v[240:255], a[228:231], v[32:35], 0
    buffer_load_dwordx4 v[72:75], v2, s[32:35], s60 offen offset:2048 sc1
    s_waitcnt vmcnt(9)
    v_mfma_f32_32x32x16_bf16 v[208:223], a[232:235], v[36:39], v[208:223]
    v_mfma_f32_32x32x16_bf16 v[240:255], a[236:239], v[36:39], v[240:255]
    buffer_load_dwordx4 v[76:79], v2, s[32:35], s60 offen offset:3072 sc1
    s_add_u32 s60, s60, 4096
    s_waitcnt vmcnt(9)
    v_mfma_f32_32x32x16_bf16 v[208:223], a[240:243], v[40:43], v[208:223]
    v_mfma_f32_32x32x16_bf16 v[240:255], a[244:247], v[40:43], v[240:255]
    buffer_load_dwordx4 v[80:83], v2, s[32:35], s60 offen offset:0 sc1
    s_waitcnt vmcnt(9)
    v_mfma_f32_32x32x16_bf16 v[208:223], a[248:251], v[44:47], v[208:223]
    v_mfma_f32_32x32x16_bf16 v[240:255], a[252:255], v[44:47], v[240:255]
    buffer_load_dwordx4 v[84:87], v2, s[32:35], s60 offen offset:1024 sc1
    s_waitcnt vmcnt(9)
    v_mfma_f32_32x32x16_bf16 v[208:223], a[0:3], v[48:51], v[208:223]
    v_mfma_f32_32x32x16_bf16 v[240:255], a[4:7], v[48:51], v[240:255]
    buffer_load_dwordx4 v[88:91], v2, s[32:35], s60 offen offset:2048 sc1
    s_waitcnt vmcnt(9)
    v_mfma_f32_32x32x16_bf16 v[208:223], a[8:11], v[52:55], v[208:223]
    v_mfma_f32_32x32x16_bf16 v[240:255], a[12:15], v[52:55], v[240:255]
    buffer_load_dwordx4 v[92:95], v2, s[32:35], s60 offen offset:3072 sc1
    s_add_u32 s60, s60, 4096
    s_waitcnt vmcnt(9)
    v_mfma_f32_32x32x16_bf16 v[208:223], a[16:19], v[56:59], v[208:223]
    v_mfma_f32_32x32x16_bf16 v[240:255], a[20:23], v[56:59], v[240:255]
    buffer_load_dwordx4 v[96:99], v2, s[32:35], s60 offen offset:0 sc1
    s_waitcnt vmcnt(9)
    v_mfma_f32_32x32x16_bf16 v[208:223], a[24:27], v[60:63], v[208:223]
    v_mfma_f32_32x32x16_bf16 v[240:255], a[28:31], v[60:63], v[240:255]
    buffer_load_dwordx4 v[100:103], v2, s[32:35], s60 offen offset:1024 sc1
    s_waitcnt vmcnt(9)
    v_mfma_f32_32x32x16_bf16 v[208:223], a[32:35], v[64:67], v[208:223]
    v_mfma_f32_32x32x16_bf16 v[240:255], a[36:39], v[64:67], v[240:255]
    buffer_load_dwordx4 v[104:107], v2, s[32:35], s60 offen offset:2048 sc1
    s_waitcnt vmcnt(9)
    v_mfma_f32_32x32x16_bf16 v[208:223], a[40:43], v[68:71], v[208:223]
    v_mfma_f32_32x32x16_bf16 v[240:255], a[44:47], v[68:71], v[240:255]
    buffer_load_dwordx4 v[108:111], v2, s[32:35], s60 offen offset:3072 sc1
    s_add_u32 s60, s60, 4096
    s_waitcnt vmcnt(9)
    v_mfma_f32_32x32x16_bf16 v[208:223], a[48:51], v[72:75], v[208:223]
    v_mfma_f32_32x32x16_bf16 v[240:255], a[52:55], v[72:75], v[240:255]
    buffer_load_dwordx4 v[112:115], v2, s[32:35], s60 offen offset:0 sc1
    s_waitcnt vmcnt(9)
    v_mfma_f32_32x32x16_bf16 v[208:223], a[56:59], v[76:79], v[208:223]
    v_mfma_f32_32x32x16_bf16 v[240:255], a[60:63], v[76:79], v[240:255]
    buffer_load_dwordx4 v[116:119], v2, s[32:35], s60 offen offset:1024 sc1
    s_waitcnt vmcnt(9)
    v_mfma_f32_32x32x16_bf16 v[208:223], a[64:67], v[80:83], v[208:223]
    v_mfma_f32_32x32x16_bf16 v[240:255], a[68:71], v[80:83], v[240:255]
    buffer_load_dwordx4 v[120:123], v2, s[32:35], s60 offen offset:2048 sc1
    s_waitcnt vmcnt(9)
    v_mfma_f32_32x32x16_bf16 v[208:223], a[72:75], v[84:87], v[208:223]
    v_mfma_f32_32x32x16_bf16 v[240:255], a[76:79], v[84:87], v[240:255]
    buffer_load_dwordx4 v[124:127], v2, s[32:35], s60 offen offset:3072 sc1
    s_add_u32 s60, s60, 4096
    s_waitcnt vmcnt(9)
    v_mfma_f32_32x32x16_bf16 v[208:223], a[80:83], v[88:91], v[208:223]
    v_mfma_f32_32x32x16_bf16 v[240:255], a[84:87], v[88:91], v[240:255]
    buffer_load_dwordx4 v[128:131], v2, s[32:35], s60 offen offset:0 sc1
    s_waitcnt vmcnt(9)
    v_mfma_f32_32x32x16_bf16 v[208:223], a[88:91], v[92:95], v[208:223]
    v_mfma_f32_32x32x16_bf16 v[240:255], a[92:95], v[92:95], v[240:255]
    buffer_load_dwordx4 v[132:135], v2, s[32:35], s60 offen offset:1024 sc1
    s_waitcnt vmcnt(9)
    v_mfma_f32_32x32x16_bf16 v[208:223], a[96:99], v[96:99], v[208:223]
    v_mfma_f32_32x32x16_bf16 v[240:255], a[100:103], v[96:99], v[240:255]
    buffer_load_dwordx4 v[136:139], v2, s[32:35], s60 offen offset:2048 sc1
    s_waitcnt vmcnt(9)
    v_mfma_f32_32x32x16_bf16 v[208:223], a[104:107], v[100:103], v[208:223]
    v_mfma_f32_32x32x16_bf16 v[240:255], a[108:111], v[100:103], v[240:255]
    buffer_load_dwordx4 v[140:143], v2, s[32:35], s60 offen offset:3072 sc1
    s_add_u32 s60, s60, 4096
    s_waitcnt vmcnt(9)
    v_mfma_f32_32x32x16_bf16 v[208:223], a[112:115], v[104:107], v[208:223]
    v_mfma_f32_32x32x16_bf16 v[240:255], a[116:119], v[104:107], v[240:255]
    s_waitcnt vmcnt(8)
    v_mfma_f32_32x32x16_bf16 v[208:223], a[120:123], v[108:111], v[208:223]
    v_mfma_f32_32x32x16_bf16 v[240:255], a[124:127], v[108:111], v[240:255]
    s_waitcnt vmcnt(7)
    v_mfma_f32_32x32x16_bf16 v[208:223], a[128:131], v[112:115], v[208:223]
    v_mfma_f32_32x32x16_bf16 v[240:255], a[132:135], v[112:115], v[240:255]
    s_waitcnt vmcnt(6)
    v_mfma_f32_32x32x16_bf16 v[208:223], a[136:139], v[116:119], v[208:223]
    v_mfma_f32_32x32x16_bf16 v[240:255], a[140:143], v[116:119], v[240:255]
    s_waitcnt vmcnt(5)
    v_mfma_f32_32x32x16_bf16 v[208:223], a[144:147], v[120:123], v[208:223]
    v_mfma_f32_32x32x16_bf16 v[240:255], a[148:151], v[120:123], v[240:255]
    s_waitcnt vmcnt(4)
    v_mfma_f32_32x32x16_bf16 v[208:223], a[152:155], v[124:127], v[208:223]
    v_mfma_f32_32x32x16_bf16 v[240:255], a[156:159], v[124:127], v[240:255]
    s_waitcnt vmcnt(3)
    v_mfma_f32_32x32x16_bf16 v[208:223], a[160:163], v[128:131], v[208:223]
    v_mfma_f32_32x32x16_bf16 v[240:255], a[164:167], v[128:131], v[240:255]
    s_waitcnt vmcnt(2)
    v_mfma_f32_32x32x16_bf16 v[208:223], a[168:171], v[132:135], v[208:223]
    v_mfma_f32_32x32x16_bf16 v[240:255], a[172:175], v[132:135], v[240:255]
    s_waitcnt vmcnt(1)
    v_mfma_f32_32x32x16_bf16 v[208:223], a[176:179], v[136:139], v[208:223]
    v_mfma_f32_32x32x16_bf16 v[240:255], a[180:183], v[136:139], v[240:255]
    s_waitcnt vmcnt(0)
    v_mfma_f32_32x32x16_bf16 v[208:223], a[184:187], v[140:143], v[208:223]
    v_mfma_f32_32x32x16_bf16 v[240:255], a[188:191], v[140:143], v[240:255]
    s_lshl_b32 s63, s3, 14
    v_add_u32 v4, s63, v2
    s_nop 9
    s_cmp_eq_u32 s3, 1
    s_cbranch_scc1 sequential_preLN__ssm_conv_s4d__glu_gated_swiglu__prompt_kernel_rw52
    s_cmp_eq_u32 s3, 2
    s_cbranch_scc1 sequential_preLN__ssm_conv_s4d__glu_gated_swiglu__prompt_kernel_rw53
    s_cmp_eq_u32 s3, 3
    s_cbranch_scc1 sequential_preLN__ssm_conv_s4d__glu_gated_swiglu__prompt_kernel_rw54
    ds_write_b128 v4, v[208:211] offset:4096
    ds_write_b128 v4, v[212:215] offset:5120
    ds_write_b128 v4, v[216:219] offset:6144
    ds_write_b128 v4, v[220:223] offset:7168
    ds_write_b128 v4, v[224:227] offset:8192
    ds_write_b128 v4, v[228:231] offset:9216
    ds_write_b128 v4, v[232:235] offset:10240
    ds_write_b128 v4, v[236:239] offset:11264
    ds_write_b128 v4, v[240:243] offset:12288
    ds_write_b128 v4, v[244:247] offset:13312
    ds_write_b128 v4, v[248:251] offset:14336
    ds_write_b128 v4, v[252:255] offset:15360
    v_pk_mov_b32 v[112:113], v[192:193], v[192:193] op_sel:[0,1]
    v_pk_mov_b32 v[114:115], v[194:195], v[194:195] op_sel:[0,1]
    v_pk_mov_b32 v[116:117], v[196:197], v[196:197] op_sel:[0,1]
    v_pk_mov_b32 v[118:119], v[198:199], v[198:199] op_sel:[0,1]
    v_pk_mov_b32 v[120:121], v[200:201], v[200:201] op_sel:[0,1]
    v_pk_mov_b32 v[122:123], v[202:203], v[202:203] op_sel:[0,1]
    v_pk_mov_b32 v[124:125], v[204:205], v[204:205] op_sel:[0,1]
    v_pk_mov_b32 v[126:127], v[206:207], v[206:207] op_sel:[0,1]
    s_waitcnt lgkmcnt(0)
    s_branch sequential_preLN__ssm_conv_s4d__glu_gated_swiglu__prompt_kernel_rw50
sequential_preLN__ssm_conv_s4d__glu_gated_swiglu__prompt_kernel_rw52:
    ds_write_b128 v4, v[192:195] offset:0
    ds_write_b128 v4, v[196:199] offset:1024
    ds_write_b128 v4, v[200:203] offset:2048
    ds_write_b128 v4, v[204:207] offset:3072
    ds_write_b128 v4, v[224:227] offset:8192
    ds_write_b128 v4, v[228:231] offset:9216
    ds_write_b128 v4, v[232:235] offset:10240
    ds_write_b128 v4, v[236:239] offset:11264
    ds_write_b128 v4, v[240:243] offset:12288
    ds_write_b128 v4, v[244:247] offset:13312
    ds_write_b128 v4, v[248:251] offset:14336
    ds_write_b128 v4, v[252:255] offset:15360
    v_pk_mov_b32 v[112:113], v[208:209], v[208:209] op_sel:[0,1]
    v_pk_mov_b32 v[114:115], v[210:211], v[210:211] op_sel:[0,1]
    v_pk_mov_b32 v[116:117], v[212:213], v[212:213] op_sel:[0,1]
    v_pk_mov_b32 v[118:119], v[214:215], v[214:215] op_sel:[0,1]
    v_pk_mov_b32 v[120:121], v[216:217], v[216:217] op_sel:[0,1]
    v_pk_mov_b32 v[122:123], v[218:219], v[218:219] op_sel:[0,1]
    v_pk_mov_b32 v[124:125], v[220:221], v[220:221] op_sel:[0,1]
    v_pk_mov_b32 v[126:127], v[222:223], v[222:223] op_sel:[0,1]
    s_waitcnt lgkmcnt(0)
    s_branch sequential_preLN__ssm_conv_s4d__glu_gated_swiglu__prompt_kernel_rw50
sequential_preLN__ssm_conv_s4d__glu_gated_swiglu__prompt_kernel_rw53:
    ds_write_b128 v4, v[192:195] offset:0
    ds_write_b128 v4, v[196:199] offset:1024
    ds_write_b128 v4, v[200:203] offset:2048
    ds_write_b128 v4, v[204:207] offset:3072
    ds_write_b128 v4, v[208:211] offset:4096
    ds_write_b128 v4, v[212:215] offset:5120
    ds_write_b128 v4, v[216:219] offset:6144
    ds_write_b128 v4, v[220:223] offset:7168
    ds_write_b128 v4, v[240:243] offset:12288
    ds_write_b128 v4, v[244:247] offset:13312
    ds_write_b128 v4, v[248:251] offset:14336
    ds_write_b128 v4, v[252:255] offset:15360
    v_pk_mov_b32 v[112:113], v[224:225], v[224:225] op_sel:[0,1]
    v_pk_mov_b32 v[114:115], v[226:227], v[226:227] op_sel:[0,1]
    v_pk_mov_b32 v[116:117], v[228:229], v[228:229] op_sel:[0,1]
    v_pk_mov_b32 v[118:119], v[230:231], v[230:231] op_sel:[0,1]
    v_pk_mov_b32 v[120:121], v[232:233], v[232:233] op_sel:[0,1]
    v_pk_mov_b32 v[122:123], v[234:235], v[234:235] op_sel:[0,1]
    v_pk_mov_b32 v[124:125], v[236:237], v[236:237] op_sel:[0,1]
    v_pk_mov_b32 v[126:127], v[238:239], v[238:239] op_sel:[0,1]
    s_waitcnt lgkmcnt(0)
    s_branch sequential_preLN__ssm_conv_s4d__glu_gated_swiglu__prompt_kernel_rw50
sequential_preLN__ssm_conv_s4d__glu_gated_swiglu__prompt_kernel_rw54:
    ds_write_b128 v4, v[192:195] offset:0
    ds_write_b128 v4, v[196:199] offset:1024
    ds_write_b128 v4, v[200:203] offset:2048
    ds_write_b128 v4, v[204:207] offset:3072
    ds_write_b128 v4, v[208:211] offset:4096
    ds_write_b128 v4, v[212:215] offset:5120
    ds_write_b128 v4, v[216:219] offset:6144
    ds_write_b128 v4, v[220:223] offset:7168
    ds_write_b128 v4, v[224:227] offset:8192
    ds_write_b128 v4, v[228:231] offset:9216
    ds_write_b128 v4, v[232:235] offset:10240
    ds_write_b128 v4, v[236:239] offset:11264
    v_pk_mov_b32 v[112:113], v[240:241], v[240:241] op_sel:[0,1]
    v_pk_mov_b32 v[114:115], v[242:243], v[242:243] op_sel:[0,1]
    v_pk_mov_b32 v[116:117], v[244:245], v[244:245] op_sel:[0,1]
    v_pk_mov_b32 v[118:119], v[246:247], v[246:247] op_sel:[0,1]
    v_pk_mov_b32 v[120:121], v[248:249], v[248:249] op_sel:[0,1]
    v_pk_mov_b32 v[122:123], v[250:251], v[250:251] op_sel:[0,1]
    v_pk_mov_b32 v[124:125], v[252:253], v[252:253] op_sel:[0,1]
    v_pk_mov_b32 v[126:127], v[254:255], v[254:255] op_sel:[0,1]
    s_waitcnt lgkmcnt(0)
sequential_preLN__ssm_conv_s4d__glu_gated_swiglu__prompt_kernel_rw50:
    s_lshr_b32 s64, s3, 1
    s_and_b32 s65, s3, 1
    v_and_b32 v4, 15, v1
    v_lshrrev_b32 v4, 2, v4
    v_lshl_add_u32 v6, v3, 2, v4
    v_lshlrev_b32_e64 v6, 6, v6
    v_bfe_u32 v7, v1, 4, 1
    v_lshl_add_u32 v6, v7, 5, v6
    v_and_b32_e64 v7, 3, v1
    v_lshl_add_u32 v6, v7, 3, v6
    s_lshl_b32 s66, s3, 11
    s_add_u32 s66, s66, 65536
    v_add_u32 v6, s66, v6
    s_lshl_b32 s63, s3, 12
    v_add_u32 v5, s63, v2
    v_and_b32 v7, 31, v1
    s_movk_i32 s66, 896
    v_mul_u32_u24_e64 v7, s66, v7
    v_lshl_add_u32 v7, v3, 4, v7
    s_lshl_b32 s66, s65, 5
    s_add_u32 s66, s66, s75
    s_mul_i32 s66, s66, 28672
    s_lshl_b32 s67, s76, 7
    s_add_u32 s66, s66, s67
    s_lshl_b32 s67, s64, 6
    s_add_u32 s66, s66, s67
    s_waitcnt vmcnt(0) lgkmcnt(0)
    s_barrier
    ds_read_b64_tr_b16 v[96:97], v6 offset:0
    ds_read_b64_tr_b16 v[98:99], v6 offset:512
    ds_read_b64_tr_b16 v[100:101], v6 offset:1024
    ds_read_b64_tr_b16 v[102:103], v6 offset:1536
    s_add_u32 s63, s3, 1
    s_and_b32 s63, s63, 3
    s_lshl_b32 s63, s63, 14
    v_add_u32 v9, s63, v5
    s_add_u32 s63, s3, 2
    s_and_b32 s63, s63, 3
    s_lshl_b32 s63, s63, 14
    v_add_u32 v10, s63, v5
    s_add_u32 s63, s3, 3
    s_and_b32 s63, s63, 3
    s_lshl_b32 s63, s63, 14
    v_add_u32 v11, s63, v5
    ds_read_b128 v[32:35], v9 offset:0
    ds_read_b128 v[48:51], v10 offset:0
    ds_read_b128 v[64:67], v11 offset:0
    ds_read_b128 v[36:39], v9 offset:1024
    ds_read_b128 v[52:55], v10 offset:1024
    ds_read_b128 v[68:71], v11 offset:1024
    ds_read_b128 v[40:43], v9 offset:2048
    ds_read_b128 v[56:59], v10 offset:2048
    ds_read_b128 v[72:75], v11 offset:2048
    ds_read_b128 v[44:47], v9 offset:3072
    ds_read_b128 v[60:63], v10 offset:3072
    ds_read_b128 v[76:79], v11 offset:3072
    s_waitcnt lgkmcnt(10)
    v_pk_add_f32 v[32:33], v[32:33], v[48:49]
    s_waitcnt lgkmcnt(9)
    v_pk_add_f32 v[112:113], v[112:113], v[64:65]
    v_pk_add_f32 v[32:33], v[32:33], v[112:113]
    v_cvt_pk_bf16_f32 v144, v32, v33
    v_lshlrev_b32_e64 v146, 16, v144
    v_and_b32 v147, 0xffff0000, v144
    v_lshlrev_b32_e64 v144, 16, v96
    v_and_b32 v145, 0xffff0000, v96
    v_pk_add_f32 v[144:145], v[144:145], v[146:147]
    v_cvt_pk_bf16_f32 v136, v144, v145
    v_pk_add_f32 v[34:35], v[34:35], v[50:51]
    v_pk_add_f32 v[114:115], v[114:115], v[66:67]
    v_pk_add_f32 v[34:35], v[34:35], v[114:115]
    v_cvt_pk_bf16_f32 v148, v34, v35
    v_lshlrev_b32_e64 v150, 16, v148
    v_and_b32 v151, 0xffff0000, v148
    v_lshlrev_b32_e64 v148, 16, v97
    v_and_b32 v149, 0xffff0000, v97
    v_pk_add_f32 v[148:149], v[148:149], v[150:151]
    v_cvt_pk_bf16_f32 v137, v148, v149
    s_waitcnt lgkmcnt(7)
    v_pk_add_f32 v[36:37], v[36:37], v[52:53]
    s_waitcnt lgkmcnt(6)
    v_pk_add_f32 v[116:117], v[116:117], v[68:69]
    v_pk_add_f32 v[36:37], v[36:37], v[116:117]
    v_cvt_pk_bf16_f32 v144, v36, v37
    v_lshlrev_b32_e64 v146, 16, v144
    v_and_b32 v147, 0xffff0000, v144
    v_lshlrev_b32_e64 v144, 16, v98
    v_and_b32 v145, 0xffff0000, v98
    v_pk_add_f32 v[144:145], v[144:145], v[146:147]
    v_cvt_pk_bf16_f32 v138, v144, v145
    v_pk_add_f32 v[38:39], v[38:39], v[54:55]
    v_pk_add_f32 v[118:119], v[118:119], v[70:71]
    v_pk_add_f32 v[38:39], v[38:39], v[118:119]
    v_cvt_pk_bf16_f32 v148, v38, v39
    v_lshlrev_b32_e64 v150, 16, v148
    v_and_b32 v151, 0xffff0000, v148
    v_lshlrev_b32_e64 v148, 16, v99
    v_and_b32 v149, 0xffff0000, v99
    v_pk_add_f32 v[148:149], v[148:149], v[150:151]
    v_cvt_pk_bf16_f32 v139, v148, v149
    v_permlane32_swap_b32 v136, v138
    s_nop 0
    v_permlane32_swap_b32 v137, v139
    buffer_store_dwordx4 v[136:139], v7, s[36:39], s66 offen offset:0
    s_waitcnt lgkmcnt(4)
    v_pk_add_f32 v[40:41], v[40:41], v[56:57]
    s_waitcnt lgkmcnt(3)
    v_pk_add_f32 v[120:121], v[120:121], v[72:73]
    v_pk_add_f32 v[40:41], v[40:41], v[120:121]
    v_cvt_pk_bf16_f32 v144, v40, v41
    v_lshlrev_b32 v146, 16, v144
    v_and_b32 v147, 0xffff0000, v144
    v_lshlrev_b32_e64 v144, 16, v100
    v_and_b32 v145, 0xffff0000, v100
    v_pk_add_f32 v[144:145], v[144:145], v[146:147]
    v_cvt_pk_bf16_f32 v140, v144, v145
    v_pk_add_f32 v[42:43], v[42:43], v[58:59]
    v_pk_add_f32 v[122:123], v[122:123], v[74:75]
    v_pk_add_f32 v[42:43], v[42:43], v[122:123]
    v_cvt_pk_bf16_f32 v148, v42, v43
    v_lshlrev_b32_e64 v150, 16, v148
    v_and_b32 v151, 0xffff0000, v148
    v_lshlrev_b32_e64 v148, 16, v101
    v_and_b32 v149, 0xffff0000, v101
    v_pk_add_f32 v[148:149], v[148:149], v[150:151]
    v_cvt_pk_bf16_f32 v141, v148, v149
    s_waitcnt lgkmcnt(1)
    v_pk_add_f32 v[44:45], v[44:45], v[60:61]
    s_waitcnt lgkmcnt(0)
    v_pk_add_f32 v[124:125], v[124:125], v[76:77]
    v_pk_add_f32 v[44:45], v[44:45], v[124:125]
    v_cvt_pk_bf16_f32 v144, v44, v45
    v_lshlrev_b32_e64 v146, 16, v144
    v_and_b32 v147, 0xffff0000, v144
    v_lshlrev_b32_e64 v144, 16, v102
    v_and_b32 v145, 0xffff0000, v102
    v_pk_add_f32 v[144:145], v[144:145], v[146:147]
    v_cvt_pk_bf16_f32 v142, v144, v145
    v_pk_add_f32 v[46:47], v[46:47], v[62:63]
    v_pk_add_f32 v[126:127], v[126:127], v[78:79]
    v_pk_add_f32 v[46:47], v[46:47], v[126:127]
    v_cvt_pk_bf16_f32 v148, v46, v47
    v_lshlrev_b32_e64 v150, 16, v148
    v_and_b32 v151, 0xffff0000, v148
    v_lshlrev_b32_e64 v148, 16, v103
    v_and_b32 v149, 0xffff0000, v103
    v_pk_add_f32 v[148:149], v[148:149], v[150:151]
    v_cvt_pk_bf16_f32 v143, v148, v149
    v_permlane32_swap_b32 v140, v142
    s_nop 0
    v_permlane32_swap_b32 v141, v143
    buffer_store_dwordx4 v[140:143], v7, s[36:39], s66 offen offset:32
    s_branch sequential_preLN__ssm_conv_s4d__glu_gated_swiglu__prompt_kernel_done
sequential_preLN__ssm_conv_s4d__glu_gated_swiglu__prompt_kernel_helper2:
    s_cmp_lg_u32 s2, 255
    s_cbranch_scc1 sequential_preLN__ssm_conv_s4d__glu_gated_swiglu__prompt_kernel_nozero56
    v_mov_b32 v152, 0
    v_mov_b32 v153, 0
    v_mov_b32 v154, 0
    v_mov_b32 v155, 0
    s_lshl_b32 s58, s3, 12
    s_add_u32 s58, s58, 17661952
    buffer_store_dwordx4 v[152:155], v2, s[32:35], s58 offen offset:0 sc1
    buffer_store_dwordx4 v[152:155], v2, s[32:35], s58 offen offset:1024 sc1
    buffer_store_dwordx4 v[152:155], v2, s[32:35], s58 offen offset:2048 sc1
    buffer_store_dwordx4 v[152:155], v2, s[32:35], s58 offen offset:3072 sc1
sequential_preLN__ssm_conv_s4d__glu_gated_swiglu__prompt_kernel_nozero56:
    s_mul_i32 s53, s3, 1920
    s_add_u32 s53, s53, 147520
    v_add_u32_e64 v4, s53, v2
    s_mov_b32 exec_hi, 0x00ffffff
    s_waitcnt vmcnt(1)
    ds_write_b128 v4, v[96:99] offset:0
    s_waitcnt vmcnt(0)
    ds_write_b128 v4, v[100:103] offset:960
    s_mov_b32 exec_hi, -1
    v_and_b32 v5, 15, v1
    v_lshrrev_b32_e64 v5, 2, v5
    v_mul_u32_u24 v5, 960, v5
    v_lshrrev_b32_e64 v6, 4, v1
    v_lshl_add_u32 v5, v6, 5, v5
    v_and_b32_e64 v6, 3, v1
    v_lshl_add_u32 v5, v6, 3, v5
    s_lshl_b32 s53, s3, 8
    s_add_u32 s53, s53, 147520
    v_add_u32 v5, s53, v5
    s_waitcnt lgkmcnt(0)
    s_barrier
    ds_read_b64_tr_b16 v[104:105], v5 offset:0
    ds_read_b64_tr_b16 v[106:107], v5 offset:3840
    ds_read_b64_tr_b16 v[108:109], v5 offset:128
    ds_read_b64_tr_b16 v[110:111], v5 offset:3968
    s_mul_i32 s53, s2, 7168
    s_lshl_b32 s54, s3, 11
    s_add_u32 s53, s53, s54
    s_add_u32 s53, s53, 0
    s_waitcnt lgkmcnt(2)
    buffer_store_dwordx4 v[104:107], v2, s[32:35], s53 offen sc1
    s_waitcnt lgkmcnt(0)
    s_cmp_eq_u32 s3, 3
    s_cbranch_scc1 sequential_preLN__ssm_conv_s4d__glu_gated_swiglu__prompt_kernel_xt357
    buffer_store_dwordx4 v[108:111], v2, s[32:35], s53 offen offset:1024 sc1
sequential_preLN__ssm_conv_s4d__glu_gated_swiglu__prompt_kernel_xt357:
    v_lshlrev_b32 v104, 16, v96
    v_and_b32 v105, 0xffff0000, v96
    v_lshlrev_b32_e64 v106, 16, v97
    v_and_b32 v107, 0xffff0000, v97
    v_lshlrev_b32_e64 v108, 16, v98
    v_and_b32 v109, 0xffff0000, v98
    v_lshlrev_b32_e64 v110, 16, v99
    v_and_b32 v111, 0xffff0000, v99
    v_lshlrev_b32_e64 v112, 16, v100
    v_and_b32 v113, 0xffff0000, v100
    v_lshlrev_b32_e64 v114, 16, v101
    v_and_b32 v115, 0xffff0000, v101
    v_lshlrev_b32_e64 v116, 16, v102
    v_and_b32 v117, 0xffff0000, v102
    v_lshlrev_b32_e64 v118, 16, v103
    v_and_b32 v119, 0xffff0000, v103
    v_pk_add_f32 v[76:77], v[104:105], v[106:107]
    v_pk_mul_f32 v[78:79], v[104:105], v[104:105]
    v_pk_add_f32 v[80:81], v[112:113], v[114:115]
    v_pk_mul_f32 v[82:83], v[112:113], v[112:113]
    v_pk_fma_f32 v[78:79], v[106:107], v[106:107], v[78:79]
    v_pk_fma_f32 v[82:83], v[114:115], v[114:115], v[82:83]
    v_pk_add_f32 v[76:77], v[76:77], v[108:109]
    v_pk_fma_f32 v[78:79], v[108:109], v[108:109], v[78:79]
    v_pk_add_f32 v[80:81], v[80:81], v[116:117]
    v_pk_fma_f32 v[82:83], v[116:117], v[116:117], v[82:83]
    v_pk_add_f32 v[76:77], v[76:77], v[110:111]
    v_pk_fma_f32 v[78:79], v[110:111], v[110:111], v[78:79]
    v_pk_add_f32 v[80:81], v[80:81], v[118:119]
    v_pk_fma_f32 v[82:83], v[118:119], v[118:119], v[82:83]
    v_add_f32 v76, v76, v77
    v_add_f32 v78, v78, v79
    v_add_f32 v80, v80, v81
    v_add_f32 v82, v82, v83
    v_add_f32_dpp v76, v76, v76 row_shr:1 row_mask:0xf bank_mask:0xf bound_ctrl:0
    v_add_f32_dpp v80, v80, v80 row_shr:1 row_mask:0xf bank_mask:0xf bound_ctrl:0
    v_add_f32_dpp v78, v78, v78 row_shr:1 row_mask:0xf bank_mask:0xf bound_ctrl:0
    v_add_f32_dpp v82, v82, v82 row_shr:1 row_mask:0xf bank_mask:0xf bound_ctrl:0
    v_add_f32_dpp v76, v76, v76 row_shr:2 row_mask:0xf bank_mask:0xf bound_ctrl:0
    v_add_f32_dpp v80, v80, v80 row_shr:2 row_mask:0xf bank_mask:0xf bound_ctrl:0
    v_add_f32_dpp v78, v78, v78 row_shr:2 row_mask:0xf bank_mask:0xf bound_ctrl:0
    v_add_f32_dpp v82, v82, v82 row_shr:2 row_mask:0xf bank_mask:0xf bound_ctrl:0
    v_add_f32_dpp v76, v76, v76 row_shr:4 row_mask:0xf bank_mask:0xf bound_ctrl:0
    v_add_f32_dpp v80, v80, v80 row_shr:4 row_mask:0xf bank_mask:0xf bound_ctrl:0
    v_add_f32_dpp v78, v78, v78 row_shr:4 row_mask:0xf bank_mask:0xf bound_ctrl:0
    v_add_f32_dpp v82, v82, v82 row_shr:4 row_mask:0xf bank_mask:0xf bound_ctrl:0
    v_add_f32_dpp v76, v76, v76 row_shr:8 row_mask:0xf bank_mask:0xf bound_ctrl:0
    v_add_f32_dpp v80, v80, v80 row_shr:8 row_mask:0xf bank_mask:0xf bound_ctrl:0
    v_add_f32_dpp v78, v78, v78 row_shr:8 row_mask:0xf bank_mask:0xf bound_ctrl:0
    v_add_f32_dpp v82, v82, v82 row_shr:8 row_mask:0xf bank_mask:0xf bound_ctrl:0
    v_add_f32_dpp v76, v76, v76 row_bcast:15 row_mask:0xa bank_mask:0xf
    v_add_f32_dpp v80, v80, v80 row_bcast:15 row_mask:0xa bank_mask:0xf
    v_add_f32_dpp v78, v78, v78 row_bcast:15 row_mask:0xa bank_mask:0xf
    v_add_f32_dpp v82, v82, v82 row_bcast:15 row_mask:0xa bank_mask:0xf
    v_add_f32_dpp v76, v76, v76 row_bcast:31 row_mask:0xc bank_mask:0xf
    v_add_f32_dpp v80, v80, v80 row_bcast:31 row_mask:0xc bank_mask:0xf
    v_add_f32_dpp v78, v78, v78 row_bcast:31 row_mask:0xc bank_mask:0xf
    v_add_f32_dpp v82, v82, v82 row_bcast:31 row_mask:0xc bank_mask:0xf
    v_mul_f32 v76, 0x3b124925, v76
    v_mul_f32 v78, 0x3b124925, v78
    v_mul_f32 v80, 0x3b124925, v80
    v_mul_f32 v82, 0x3b124925, v82
    v_fma_f32 v78, -v76, v76, v78
    v_fma_f32 v82, -v80, v80, v82
    v_cvt_pk_bf16_f32 v77, v76, v78
    v_cvt_pk_bf16_f32 v81, v80, v82
    v_and_b32 v78, 0xffff0000, v77
    v_and_b32 v82, 0xffff0000, v81
    v_add_f32 v78, 0x3727c5ac, v78
    v_add_f32 v82, 0x3727c5ac, v82
    v_cvt_pk_bf16_f32 v78, v78, v78
    v_cvt_pk_bf16_f32 v82, v82, v82
    v_and_b32 v78, 0xffff0000, v78
    v_and_b32 v82, 0xffff0000, v82
    v_sqrt_f32 v78, v78
    v_sqrt_f32 v82, v82
    s_mov_b32 s52, 0x9E3779B1
    v_mul_lo_u32 v239, v239, s52
    v_add_u32 v239, 0x7F4A7C15, v239
    v_max_u32 v239, 1, v239
    s_nop 0
    v_readfirstlane_b32 s71, v239
    v_cvt_pk_bf16_f32 v78, v78, v78
    v_cvt_pk_bf16_f32 v82, v82, v82
    s_mov_b32 s53, 0xffff
    v_bfi_b32 v84, s53, v77, v78
    v_mov_b32 v85, s71
    v_bfi_b32 v86, s53, v81, v82
    v_mov_b32 v87, s71
    s_lshl_b32 s53, s3, 4
    s_add_u32 s53, s53, 147456
    v_mov_b32 v4, s53
    s_mov_b32 exec_lo, 0
    s_mov_b32 exec_hi, 0x80000000
    ds_write_b128 v4, v[84:87]
    s_mov_b64 exec, -1
    s_waitcnt vmcnt(0) lgkmcnt(0)
    s_barrier
    s_cmp_lg_u32 s3, 0
    s_cbranch_scc1 sequential_preLN__ssm_conv_s4d__glu_gated_swiglu__prompt_kernel_gst58
    v_add_u32 v4, 147456, v2
    s_mov_b32 exec_lo, 15
    s_mov_b32 exec_hi, 0
    ds_read_b128 v[60:63], v4
    s_lshl_b32 s53, s2, 7
    s_add_u32 s53, s53, 17809408
    s_waitcnt lgkmcnt(0)
    buffer_store_dwordx4 v[60:63], v2, s[32:35], s53 offen sc1
    s_mov_b64 exec, -1
sequential_preLN__ssm_conv_s4d__glu_gated_swiglu__prompt_kernel_gst58:
    s_mov_b32 s40, s20
    s_mov_b32 s41, s21
    s_mov_b32 s42, 1605632
    s_mov_b32 s43, 0x20000
    s_mov_b32 s44, s22
    s_mov_b32 s45, s23
    s_mov_b32 s46, 1605632
    s_mov_b32 s47, 0x20000
    s_mov_b32 s48, s24
    s_mov_b32 s49, s25
    s_mov_b32 s50, 1605632
    s_mov_b32 s51, 0x20000
    v_lshrrev_b32 v4, 3, v1
    v_and_b32 v5, 7, v1
    v_lshlrev_b32 v6, 4, v5
    s_movk_i32 s58, 3584
    v_mad_u32_u24 v250, v4, s58, v6
    s_movk_i32 s58, 896
    v_mad_u32_u24 v251, v4, s58, v6
    v_lshrrev_b32 v252, 2, v5
    v_mul_u32_u24 v252, 1088, v252
    v_lshl_add_u32 v252, v4, 6, v252
    v_and_b32_e64 v6, 3, v5
    v_lshl_add_u32 v252, v6, 4, v252
    s_mul_i32 s58, s3, 10880
    s_add_u32 s58, s58, 0
    v_add_u32 v252, s58, v252
    v_and_b32 v4, 15, v1
    v_lshrrev_b32 v4, 2, v4
    v_bfe_u32 v6, v1, 4, 1
    v_lshlrev_b32 v6, 5, v6
    v_and_b32 v5, 3, v1
    v_lshl_add_u32 v6, v5, 3, v6
    v_lshl_add_u32 v6, v4, 6, v6
    v_add_u32_e64 v6, s58, v6
    v_lshl_add_u32 v253, v3, 9, v6
    v_lshl_add_u32 v254, v3, 8, v6
    s_sub_u32 s79, s2, 224
    s_lshl_b32 s79, s79, 2
    s_add_u32 s79, s79, s3
    s_cmp_ge_u32 s79, 112
    s_cbranch_scc1 sequential_preLN__ssm_conv_s4d__glu_gated_swiglu__prompt_kernel_nosw255
    s_mul_i32 s78, s79, 5
    s_add_u32 s78, s78, 224
    s_mul_i32 s62, s78, 9363
    s_lshr_b32 s62, s62, 16
    s_mul_i32 s63, s62, 7
    s_sub_u32 s63, s78, s63
    s_mul_i32 s65, s62, 14336
    s_lshl_b32 s64, s63, 7
    s_add_u32 s65, s65, s64
    s_mul_i32 s72, s63, 112
    s_add_u32 s72, s72, s62
    s_lshl_b32 s72, s72, 11
    s_add_u32 s72, s72, 8716288
    buffer_load_dwordx4 v[16:19], v251, s[48:51], s65 offen
    s_add_u32 s62, s65, 7168
    buffer_load_dwordx4 v[20:23], v251, s[48:51], s62 offen
    s_add_u32 s78, s78, 1
    s_mul_i32 s62, s78, 9363
    s_lshr_b32 s62, s62, 16
    s_mul_i32 s63, s62, 7
    s_sub_u32 s63, s78, s63
    s_mul_i32 s65, s62, 14336
    s_lshl_b32 s64, s63, 7
    s_add_u32 s65, s65, s64
    s_mul_i32 s73, s63, 112
    s_add_u32 s73, s73, s62
    s_lshl_b32 s73, s73, 11
    s_add_u32 s73, s73, 8716288
    buffer_load_dwordx4 v[24:27], v251, s[48:51], s65 offen
    s_add_u32 s62, s65, 7168
    buffer_load_dwordx4 v[28:31], v251, s[48:51], s62 offen
    s_add_u32 s78, s78, 1
    s_mul_i32 s62, s78, 9363
    s_lshr_b32 s62, s62, 16
    s_mul_i32 s63, s62, 7
    s_sub_u32 s63, s78, s63
    s_mul_i32 s65, s62, 14336
    s_lshl_b32 s64, s63, 7
    s_add_u32 s65, s65, s64
    s_mul_i32 s74, s63, 112
    s_add_u32 s74, s74, s62
    s_lshl_b32 s74, s74, 11
    s_add_u32 s74, s74, 8716288
    buffer_load_dwordx4 v[32:35], v251, s[48:51], s65 offen
    s_add_u32 s62, s65, 7168
    buffer_load_dwordx4 v[36:39], v251, s[48:51], s62 offen
    s_add_u32 s78, s78, 1
    s_mul_i32 s62, s78, 9363
    s_lshr_b32 s62, s62, 16
    s_mul_i32 s63, s62, 7
    s_sub_u32 s63, s78, s63
    s_mul_i32 s65, s62, 14336
    s_lshl_b32 s64, s63, 7
    s_add_u32 s65, s65, s64
    s_mul_i32 s75, s63, 112
    s_add_u32 s75, s75, s62
    s_lshl_b32 s75, s75, 11
    s_add_u32 s75, s75, 8716288
    buffer_load_dwordx4 v[40:43], v251, s[48:51], s65 offen
    s_add_u32 s62, s65, 7168
    buffer_load_dwordx4 v[44:47], v251, s[48:51], s62 offen
    s_add_u32 s78, s78, 1
    s_mul_i32 s62, s78, 9363
    s_lshr_b32 s62, s62, 16
    s_mul_i32 s63, s62, 7
    s_sub_u32 s63, s78, s63
    s_mul_i32 s65, s62, 14336
    s_lshl_b32 s64, s63, 7
    s_add_u32 s65, s65, s64
    s_mul_i32 s76, s63, 112
    s_add_u32 s76, s76, s62
    s_lshl_b32 s76, s76, 11
    s_add_u32 s76, s76, 8716288
    buffer_load_dwordx4 v[48:51], v251, s[48:51], s65 offen
    s_add_u32 s62, s65, 7168
    buffer_load_dwordx4 v[52:55], v251, s[48:51], s62 offen
    s_waitcnt vmcnt(9)
    ds_write_b128 v252, v[16:19] offset:0
    s_waitcnt vmcnt(8)
    ds_write_b128 v252, v[20:23] offset:512
    ds_read_b64_tr_b16 v[64:65], v254 offset:0
    ds_read_b64_tr_b16 v[66:67], v254 offset:512
    ds_read_b64_tr_b16 v[68:69], v254 offset:1088
    ds_read_b64_tr_b16 v[70:71], v254 offset:1600
    s_waitcnt vmcnt(7)
    ds_write_b128 v252, v[24:27] offset:2176
    s_waitcnt vmcnt(6)
    ds_write_b128 v252, v[28:31] offset:2688
    ds_read_b64_tr_b16 v[72:73], v254 offset:2176
    ds_read_b64_tr_b16 v[74:75], v254 offset:2688
    ds_read_b64_tr_b16 v[76:77], v254 offset:3264
    ds_read_b64_tr_b16 v[78:79], v254 offset:3776
    s_waitcnt vmcnt(5)
    ds_write_b128 v252, v[32:35] offset:4352
    s_waitcnt vmcnt(4)
    ds_write_b128 v252, v[36:39] offset:4864
    ds_read_b64_tr_b16 v[80:81], v254 offset:4352
    ds_read_b64_tr_b16 v[82:83], v254 offset:4864
    ds_read_b64_tr_b16 v[84:85], v254 offset:5440
    ds_read_b64_tr_b16 v[86:87], v254 offset:5952
    s_waitcnt vmcnt(3)
    ds_write_b128 v252, v[40:43] offset:6528
    s_waitcnt vmcnt(2)
    ds_write_b128 v252, v[44:47] offset:7040
    ds_read_b64_tr_b16 v[88:89], v254 offset:6528
    ds_read_b64_tr_b16 v[90:91], v254 offset:7040
    ds_read_b64_tr_b16 v[92:93], v254 offset:7616
    ds_read_b64_tr_b16 v[94:95], v254 offset:8128
    s_waitcnt vmcnt(1)
    ds_write_b128 v252, v[48:51] offset:8704
    s_waitcnt vmcnt(0)
    ds_write_b128 v252, v[52:55] offset:9216
    ds_read_b64_tr_b16 v[96:97], v254 offset:8704
    ds_read_b64_tr_b16 v[98:99], v254 offset:9216
    ds_read_b64_tr_b16 v[100:101], v254 offset:9792
    ds_read_b64_tr_b16 v[102:103], v254 offset:10304
    s_add_u32 s62, s72, 0
    buffer_store_dwordx4 v[64:67], v2, s[32:35], s62 offen sc1
    s_add_u32 s62, s72, 1024
    buffer_store_dwordx4 v[68:71], v2, s[32:35], s62 offen sc1
    s_add_u32 s62, s73, 0
    buffer_store_dwordx4 v[72:75], v2, s[32:35], s62 offen sc1
    s_add_u32 s62, s73, 1024
    buffer_store_dwordx4 v[76:79], v2, s[32:35], s62 offen sc1
    s_add_u32 s62, s74, 0
    s_waitcnt lgkmcnt(14)
    buffer_store_dwordx4 v[80:83], v2, s[32:35], s62 offen sc1
    s_add_u32 s62, s74, 1024
    s_waitcnt lgkmcnt(12)
    buffer_store_dwordx4 v[84:87], v2, s[32:35], s62 offen sc1
    s_add_u32 s62, s75, 0
    s_waitcnt lgkmcnt(8)
    buffer_store_dwordx4 v[88:91], v2, s[32:35], s62 offen sc1
    s_add_u32 s62, s75, 1024
    s_waitcnt lgkmcnt(6)
    buffer_store_dwordx4 v[92:95], v2, s[32:35], s62 offen sc1
    s_add_u32 s62, s76, 0
    s_waitcnt lgkmcnt(2)
    buffer_store_dwordx4 v[96:99], v2, s[32:35], s62 offen sc1
    s_add_u32 s62, s76, 1024
    s_waitcnt lgkmcnt(0)
    buffer_store_dwordx4 v[100:103], v2, s[32:35], s62 offen sc1
sequential_preLN__ssm_conv_s4d__glu_gated_swiglu__prompt_kernel_nosw255:
    s_waitcnt vmcnt(0) lgkmcnt(0)
    s_barrier
    s_cmp_lg_u32 s3, 0
    s_cbranch_scc1 sequential_preLN__ssm_conv_s4d__glu_gated_swiglu__prompt_kernel_fs59
    s_lshl_b32 s52, s2, 7
    s_add_u32 s52, s52, 17842176
    v_lshlrev_b32 v4, 2, v1
    v_mov_b32 v5, s71
    s_mov_b32 exec_hi, 0
    buffer_store_dword v5, v4, s[32:35], s52 offen sc1
    s_mov_b32 exec_hi, -1
sequential_preLN__ssm_conv_s4d__glu_gated_swiglu__prompt_kernel_fs59:
    s_lshl_b32 s53, s3, 13
    s_add_u32 s53, s53, 17842176
    v_lshlrev_b32 v4, 7, v1
    s_mov_b32 s52, 0
sequential_preLN__ssm_conv_s4d__glu_gated_swiglu__prompt_kernel_fw60:
    buffer_load_dword v5, v4, s[32:35], s53 offen sc1
    s_add_u32 s52, s52, 1
    s_waitcnt vmcnt(0) lgkmcnt(0)
    v_cmp_ne_u32 vcc, s71, v5
    s_cmp_ge_u32 s52, 400000
    s_nop 3
    s_cbranch_scc1 sequential_preLN__ssm_conv_s4d__glu_gated_swiglu__prompt_kernel_fwe61
    s_nop 3
    s_cmp_eq_u64 vcc, 0
    s_cbranch_scc0 sequential_preLN__ssm_conv_s4d__glu_gated_swiglu__prompt_kernel_fw60
sequential_preLN__ssm_conv_s4d__glu_gated_swiglu__prompt_kernel_fwe61:
    s_barrier
    s_cmp_ge_u32 s79, 112
    s_cbranch_scc1 sequential_preLN__ssm_conv_s4d__glu_gated_swiglu__prompt_kernel_nocs62
    s_lshr_b32 s53, s79, 1
    s_and_b32 s55, s79, 1
    s_mul_i32 s54, s53, 57344
    s_lshl_b32 s56, s55, 10
    s_add_u32 s54, s54, s56
    s_add_u32 s54, s54, 5505024
    buffer_load_dwordx4 a[0:3], v2, s[32:35], s54 offen offset:0 sc1
    buffer_load_dwordx4 a[4:7], v2, s[32:35], s54 offen offset:2048 sc1
    s_add_u32 s54, s54, 4096
    buffer_load_dwordx4 a[8:11], v2, s[32:35], s54 offen offset:0 sc1
    buffer_load_dwordx4 a[12:15], v2, s[32:35], s54 offen offset:2048 sc1
    s_add_u32 s54, s54, 4096
    buffer_load_dwordx4 a[16:19], v2, s[32:35], s54 offen offset:0 sc1
    buffer_load_dwordx4 a[20:23], v2, s[32:35], s54 offen offset:2048 sc1
    s_add_u32 s54, s54, 4096
    buffer_load_dwordx4 a[24:27], v2, s[32:35], s54 offen offset:0 sc1
    buffer_load_dwordx4 a[28:31], v2, s[32:35], s54 offen offset:2048 sc1
    s_add_u32 s54, s54, 4096
    buffer_load_dwordx4 a[32:35], v2, s[32:35], s54 offen offset:0 sc1
    buffer_load_dwordx4 a[36:39], v2, s[32:35], s54 offen offset:2048 sc1
    s_add_u32 s54, s54, 4096
    buffer_load_dwordx4 a[40:43], v2, s[32:35], s54 offen offset:0 sc1
    buffer_load_dwordx4 a[44:47], v2, s[32:35], s54 offen offset:2048 sc1
    s_add_u32 s54, s54, 4096
    buffer_load_dwordx4 a[48:51], v2, s[32:35], s54 offen offset:0 sc1
    buffer_load_dwordx4 a[52:55], v2, s[32:35], s54 offen offset:2048 sc1
    s_add_u32 s54, s54, 4096
    buffer_load_dwordx4 a[56:59], v2, s[32:35], s54 offen offset:0 sc1
    buffer_load_dwordx4 a[60:63], v2, s[32:35], s54 offen offset:2048 sc1
    s_add_u32 s54, s54, 4096
    buffer_load_dwordx4 a[64:67], v2, s[32:35], s54 offen offset:0 sc1
    buffer_load_dwordx4 a[68:71], v2, s[32:35], s54 offen offset:2048 sc1
    s_add_u32 s54, s54, 4096
    buffer_load_dwordx4 a[72:75], v2, s[32:35], s54 offen offset:0 sc1
    buffer_load_dwordx4 a[76:79], v2, s[32:35], s54 offen offset:2048 sc1
    s_add_u32 s54, s54, 4096
    buffer_load_dwordx4 a[80:83], v2, s[32:35], s54 offen offset:0 sc1
    buffer_load_dwordx4 a[84:87], v2, s[32:35], s54 offen offset:2048 sc1
    s_add_u32 s54, s54, 4096
    buffer_load_dwordx4 a[88:91], v2, s[32:35], s54 offen offset:0 sc1
    buffer_load_dwordx4 a[92:95], v2, s[32:35], s54 offen offset:2048 sc1
    s_add_u32 s54, s54, 4096
    buffer_load_dwordx4 a[96:99], v2, s[32:35], s54 offen offset:0 sc1
    buffer_load_dwordx4 a[100:103], v2, s[32:35], s54 offen offset:2048 sc1
    s_add_u32 s54, s54, 4096
    buffer_load_dwordx4 a[104:107], v2, s[32:35], s54 offen offset:0 sc1
    buffer_load_dwordx4 a[108:111], v2, s[32:35], s54 offen offset:2048 sc1
    s_add_u32 s54, s54, 4096
    v_mov_b32 v20, 0x3f803f80
    v_mov_b32 v21, 0x3f803f80
    v_mov_b32 v22, 0x3f803f80
    v_mov_b32 v23, 0x3f803f80
    s_waitcnt vmcnt(27)
    s_nop 0
    v_mfma_f32_32x32x16_bf16 v[32:47], v[20:23], a[0:3], 0
    s_waitcnt vmcnt(26)
    v_mfma_f32_32x32x16_bf16 v[32:47], v[20:23], a[4:7], v[32:47]
    s_waitcnt vmcnt(25)
    v_mfma_f32_32x32x16_bf16 v[32:47], v[20:23], a[8:11], v[32:47]
    s_waitcnt vmcnt(24)
    v_mfma_f32_32x32x16_bf16 v[32:47], v[20:23], a[12:15], v[32:47]
    s_waitcnt vmcnt(23)
    v_mfma_f32_32x32x16_bf16 v[32:47], v[20:23], a[16:19], v[32:47]
    s_waitcnt vmcnt(22)
    v_mfma_f32_32x32x16_bf16 v[32:47], v[20:23], a[20:23], v[32:47]
    s_waitcnt vmcnt(21)
    v_mfma_f32_32x32x16_bf16 v[32:47], v[20:23], a[24:27], v[32:47]
    s_waitcnt vmcnt(20)
    v_mfma_f32_32x32x16_bf16 v[32:47], v[20:23], a[28:31], v[32:47]
    s_waitcnt vmcnt(19)
    v_mfma_f32_32x32x16_bf16 v[32:47], v[20:23], a[32:35], v[32:47]
    s_waitcnt vmcnt(18)
    v_mfma_f32_32x32x16_bf16 v[32:47], v[20:23], a[36:39], v[32:47]
    s_waitcnt vmcnt(17)
    v_mfma_f32_32x32x16_bf16 v[32:47], v[20:23], a[40:43], v[32:47]
    s_waitcnt vmcnt(16)
    v_mfma_f32_32x32x16_bf16 v[32:47], v[20:23], a[44:47], v[32:47]
    s_waitcnt vmcnt(15)
    v_mfma_f32_32x32x16_bf16 v[32:47], v[20:23], a[48:51], v[32:47]
    s_waitcnt vmcnt(14)
    v_mfma_f32_32x32x16_bf16 v[32:47], v[20:23], a[52:55], v[32:47]
    s_waitcnt vmcnt(13)
    v_mfma_f32_32x32x16_bf16 v[32:47], v[20:23], a[56:59], v[32:47]
    s_waitcnt vmcnt(12)
    v_mfma_f32_32x32x16_bf16 v[32:47], v[20:23], a[60:63], v[32:47]
    s_waitcnt vmcnt(11)
    v_mfma_f32_32x32x16_bf16 v[32:47], v[20:23], a[64:67], v[32:47]
    s_waitcnt vmcnt(10)
    v_mfma_f32_32x32x16_bf16 v[32:47], v[20:23], a[68:71], v[32:47]
    s_waitcnt vmcnt(9)
    v_mfma_f32_32x32x16_bf16 v[32:47], v[20:23], a[72:75], v[32:47]
    s_waitcnt vmcnt(8)
    v_mfma_f32_32x32x16_bf16 v[32:47], v[20:23], a[76:79], v[32:47]
    s_waitcnt vmcnt(7)
    v_mfma_f32_32x32x16_bf16 v[32:47], v[20:23], a[80:83], v[32:47]
    s_waitcnt vmcnt(6)
    v_mfma_f32_32x32x16_bf16 v[32:47], v[20:23], a[84:87], v[32:47]
    s_waitcnt vmcnt(5)
    v_mfma_f32_32x32x16_bf16 v[32:47], v[20:23], a[88:91], v[32:47]
    s_waitcnt vmcnt(4)
    v_mfma_f32_32x32x16_bf16 v[32:47], v[20:23], a[92:95], v[32:47]
    s_waitcnt vmcnt(3)
    v_mfma_f32_32x32x16_bf16 v[32:47], v[20:23], a[96:99], v[32:47]
    s_waitcnt vmcnt(2)
    v_mfma_f32_32x32x16_bf16 v[32:47], v[20:23], a[100:103], v[32:47]
    s_waitcnt vmcnt(1)
    v_mfma_f32_32x32x16_bf16 v[32:47], v[20:23], a[104:107], v[32:47]
    s_waitcnt vmcnt(0)
    v_mfma_f32_32x32x16_bf16 v[32:47], v[20:23], a[108:111], v[32:47]
    v_cmp_gt_u32 vcc, 32, v1
    s_nop 10
    v_cvt_pk_bf16_f32 v8, v32, v32
    v_and_b32 v8, 0xffff0000, v8
    v_sub_f32 v9, v32, v8
    v_cvt_pk_bf16_f32 v10, v8, v9
    v_cndmask_b32 v64, 0, v10, vcc
    v_mov_b32 v65, 0
    v_mov_b32 v66, 0
    v_mov_b32 v67, 0
    s_lshl_b32 s54, s79, 10
    s_add_u32 s54, s54, 17694720
    buffer_store_dwordx4 v[64:67], v2, s[32:35], s54 offen sc1
    s_waitcnt vmcnt(0)
    s_mov_b64 exec, 1
    v_mov_b32 v4, 17676288
    v_mov_b32 v5, 1
    global_atomic_add v4, v5, s[30:31]
    s_mov_b64 exec, -1
sequential_preLN__ssm_conv_s4d__glu_gated_swiglu__prompt_kernel_nocs62:
    s_sub_u32 s54, s2, 224
    s_lshr_b32 s54, s54, 4
    s_lshl_b32 s54, s54, 12
    s_add_u32 s53, s54, 17661952
    s_cmp_lg_u32 s3, 0
    s_cbranch_scc1 sequential_preLN__ssm_conv_s4d__glu_gated_swiglu__prompt_kernel_wsk63
    v_mul_u32_u24 v4, 128, v1
    v_add_u32 v4, s53, v4
    s_mov_b32 exec_lo, 0xffffffff
    s_mov_b32 exec_hi, 0
    s_mov_b32 s52, 0
sequential_preLN__ssm_conv_s4d__glu_gated_swiglu__prompt_kernel_wlp64:
    global_load_dword v5, v4, s[30:31] sc1
    s_add_u32 s52, s52, 1
    s_waitcnt vmcnt(0) lgkmcnt(0)
    v_cmp_gt_u32 vcc, 7, v5
    s_cmp_ge_u32 s52, 400000
    s_nop 3
    s_cbranch_scc1 sequential_preLN__ssm_conv_s4d__glu_gated_swiglu__prompt_kernel_wex65
    s_nop 3
    s_cmp_eq_u64 vcc, 0
    s_cbranch_scc0 sequential_preLN__ssm_conv_s4d__glu_gated_swiglu__prompt_kernel_wlp64
sequential_preLN__ssm_conv_s4d__glu_gated_swiglu__prompt_kernel_wex65:
    s_mov_b64 exec, -1
sequential_preLN__ssm_conv_s4d__glu_gated_swiglu__prompt_kernel_wsk63:
    s_barrier
    s_sub_u32 s53, s2, 224
    v_lshrrev_b32 v4, 3, v1
    v_lshlrev_b32 v4, 12, v4
    v_and_b32 v5, 7, v1
    v_lshl_add_u32 v4, v5, 4, v4
    s_mul_i32 s54, s3, 458752
    s_lshl_b32 s55, s53, 7
    s_add_u32 s54, s54, s55
    s_add_u32 s54, s54, 3670016
    buffer_load_dwordx4 v[16:19], v4, s[32:35], s54 offen sc1
    s_add_u32 s54, s54, 32768
    buffer_load_dwordx4 v[20:23], v4, s[32:35], s54 offen sc1
    s_add_u32 s54, s54, 32768
    buffer_load_dwordx4 v[24:27], v4, s[32:35], s54 offen sc1
    s_add_u32 s54, s54, 32768
    buffer_load_dwordx4 v[28:31], v4, s[32:35], s54 offen sc1
    s_add_u32 s54, s54, 32768
    buffer_load_dwordx4 v[32:35], v4, s[32:35], s54 offen sc1
    s_add_u32 s54, s54, 32768
    buffer_load_dwordx4 v[36:39], v4, s[32:35], s54 offen sc1
    s_add_u32 s54, s54, 32768
    buffer_load_dwordx4 v[40:43], v4, s[32:35], s54 offen sc1
    s_add_u32 s54, s54, 32768
    buffer_load_dwordx4 v[44:47], v4, s[32:35], s54 offen sc1
    s_add_u32 s54, s54, 32768
    buffer_load_dwordx4 v[48:51], v4, s[32:35], s54 offen sc1
    s_add_u32 s54, s54, 32768
    buffer_load_dwordx4 v[52:55], v4, s[32:35], s54 offen sc1
    s_add_u32 s54, s54, 32768
    buffer_load_dwordx4 v[56:59], v4, s[32:35], s54 offen sc1
    s_add_u32 s54, s54, 32768
    buffer_load_dwordx4 v[60:63], v4, s[32:35], s54 offen sc1
    s_add_u32 s54, s54, 32768
    buffer_load_dwordx4 v[64:67], v4, s[32:35], s54 offen sc1
    s_add_u32 s54, s54, 32768
    buffer_load_dwordx4 v[68:71], v4, s[32:35], s54 offen sc1
    v_mov_b32 v80, 0
    v_mov_b32 v81, 0
    v_mov_b32 v82, 0
    v_mov_b32 v83, 0
    v_mov_b32 v84, 0
    v_mov_b32 v85, 0
    v_mov_b32 v86, 0
    v_mov_b32 v87, 0
    v_mov_b32 v88, 0
    v_mov_b32 v89, 0
    v_mov_b32 v90, 0
    v_mov_b32 v91, 0
    v_mov_b32 v92, 0
    v_mov_b32 v93, 0
    v_mov_b32 v94, 0
    v_mov_b32 v95, 0
    s_waitcnt vmcnt(13)
    v_lshlrev_b32 v100, 16, v16
    v_and_b32 v101, 0xffff0000, v16
    v_lshlrev_b32_e64 v102, 16, v17
    v_and_b32 v103, 0xffff0000, v17
    v_lshlrev_b32_e64 v104, 16, v18
    v_and_b32 v105, 0xffff0000, v18
    v_lshlrev_b32_e64 v106, 16, v19
    v_and_b32 v107, 0xffff0000, v19
    v_pk_add_f32 v[80:81], v[80:81], v[100:101]
    v_pk_fma_f32 v[88:89], v[100:101], v[100:101], v[88:89]
    v_pk_add_f32 v[82:83], v[82:83], v[102:103]
    v_pk_fma_f32 v[90:91], v[102:103], v[102:103], v[90:91]
    v_pk_add_f32 v[84:85], v[84:85], v[104:105]
    v_pk_fma_f32 v[92:93], v[104:105], v[104:105], v[92:93]
    v_pk_add_f32 v[86:87], v[86:87], v[106:107]
    v_pk_fma_f32 v[94:95], v[106:107], v[106:107], v[94:95]
    s_waitcnt vmcnt(12)
    v_lshlrev_b32 v100, 16, v20
    v_and_b32 v101, 0xffff0000, v20
    v_lshlrev_b32_e64 v102, 16, v21
    v_and_b32 v103, 0xffff0000, v21
    v_lshlrev_b32_e64 v104, 16, v22
    v_and_b32 v105, 0xffff0000, v22
    v_lshlrev_b32_e64 v106, 16, v23
    v_and_b32 v107, 0xffff0000, v23
    v_pk_add_f32 v[80:81], v[80:81], v[100:101]
    v_pk_fma_f32 v[88:89], v[100:101], v[100:101], v[88:89]
    v_pk_add_f32 v[82:83], v[82:83], v[102:103]
    v_pk_fma_f32 v[90:91], v[102:103], v[102:103], v[90:91]
    v_pk_add_f32 v[84:85], v[84:85], v[104:105]
    v_pk_fma_f32 v[92:93], v[104:105], v[104:105], v[92:93]
    v_pk_add_f32 v[86:87], v[86:87], v[106:107]
    v_pk_fma_f32 v[94:95], v[106:107], v[106:107], v[94:95]
    s_waitcnt vmcnt(11)
    v_lshlrev_b32 v100, 16, v24
    v_and_b32 v101, 0xffff0000, v24
    v_lshlrev_b32_e64 v102, 16, v25
    v_and_b32 v103, 0xffff0000, v25
    v_lshlrev_b32_e64 v104, 16, v26
    v_and_b32 v105, 0xffff0000, v26
    v_lshlrev_b32_e64 v106, 16, v27
    v_and_b32 v107, 0xffff0000, v27
    v_pk_add_f32 v[80:81], v[80:81], v[100:101]
    v_pk_fma_f32 v[88:89], v[100:101], v[100:101], v[88:89]
    v_pk_add_f32 v[82:83], v[82:83], v[102:103]
    v_pk_fma_f32 v[90:91], v[102:103], v[102:103], v[90:91]
    v_pk_add_f32 v[84:85], v[84:85], v[104:105]
    v_pk_fma_f32 v[92:93], v[104:105], v[104:105], v[92:93]
    v_pk_add_f32 v[86:87], v[86:87], v[106:107]
    v_pk_fma_f32 v[94:95], v[106:107], v[106:107], v[94:95]
    s_waitcnt vmcnt(10)
    v_lshlrev_b32 v100, 16, v28
    v_and_b32 v101, 0xffff0000, v28
    v_lshlrev_b32_e64 v102, 16, v29
    v_and_b32 v103, 0xffff0000, v29
    v_lshlrev_b32_e64 v104, 16, v30
    v_and_b32 v105, 0xffff0000, v30
    v_lshlrev_b32_e64 v106, 16, v31
    v_and_b32 v107, 0xffff0000, v31
    v_pk_add_f32 v[80:81], v[80:81], v[100:101]
    v_pk_fma_f32 v[88:89], v[100:101], v[100:101], v[88:89]
    v_pk_add_f32 v[82:83], v[82:83], v[102:103]
    v_pk_fma_f32 v[90:91], v[102:103], v[102:103], v[90:91]
    v_pk_add_f32 v[84:85], v[84:85], v[104:105]
    v_pk_fma_f32 v[92:93], v[104:105], v[104:105], v[92:93]
    v_pk_add_f32 v[86:87], v[86:87], v[106:107]
    v_pk_fma_f32 v[94:95], v[106:107], v[106:107], v[94:95]
    s_waitcnt vmcnt(9)
    v_lshlrev_b32 v100, 16, v32
    v_and_b32 v101, 0xffff0000, v32
    v_lshlrev_b32_e64 v102, 16, v33
    v_and_b32 v103, 0xffff0000, v33
    v_lshlrev_b32_e64 v104, 16, v34
    v_and_b32 v105, 0xffff0000, v34
    v_lshlrev_b32_e64 v106, 16, v35
    v_and_b32 v107, 0xffff0000, v35
    v_pk_add_f32 v[80:81], v[80:81], v[100:101]
    v_pk_fma_f32 v[88:89], v[100:101], v[100:101], v[88:89]
    v_pk_add_f32 v[82:83], v[82:83], v[102:103]
    v_pk_fma_f32 v[90:91], v[102:103], v[102:103], v[90:91]
    v_pk_add_f32 v[84:85], v[84:85], v[104:105]
    v_pk_fma_f32 v[92:93], v[104:105], v[104:105], v[92:93]
    v_pk_add_f32 v[86:87], v[86:87], v[106:107]
    v_pk_fma_f32 v[94:95], v[106:107], v[106:107], v[94:95]
    s_waitcnt vmcnt(8)
    v_lshlrev_b32 v100, 16, v36
    v_and_b32 v101, 0xffff0000, v36
    v_lshlrev_b32_e64 v102, 16, v37
    v_and_b32 v103, 0xffff0000, v37
    v_lshlrev_b32_e64 v104, 16, v38
    v_and_b32 v105, 0xffff0000, v38
    v_lshlrev_b32_e64 v106, 16, v39
    v_and_b32 v107, 0xffff0000, v39
    v_pk_add_f32 v[80:81], v[80:81], v[100:101]
    v_pk_fma_f32 v[88:89], v[100:101], v[100:101], v[88:89]
    v_pk_add_f32 v[82:83], v[82:83], v[102:103]
    v_pk_fma_f32 v[90:91], v[102:103], v[102:103], v[90:91]
    v_pk_add_f32 v[84:85], v[84:85], v[104:105]
    v_pk_fma_f32 v[92:93], v[104:105], v[104:105], v[92:93]
    v_pk_add_f32 v[86:87], v[86:87], v[106:107]
    v_pk_fma_f32 v[94:95], v[106:107], v[106:107], v[94:95]
    s_waitcnt vmcnt(7)
    v_lshlrev_b32 v100, 16, v40
    v_and_b32 v101, 0xffff0000, v40
    v_lshlrev_b32_e64 v102, 16, v41
    v_and_b32 v103, 0xffff0000, v41
    v_lshlrev_b32_e64 v104, 16, v42
    v_and_b32 v105, 0xffff0000, v42
    v_lshlrev_b32_e64 v106, 16, v43
    v_and_b32 v107, 0xffff0000, v43
    v_pk_add_f32 v[80:81], v[80:81], v[100:101]
    v_pk_fma_f32 v[88:89], v[100:101], v[100:101], v[88:89]
    v_pk_add_f32 v[82:83], v[82:83], v[102:103]
    v_pk_fma_f32 v[90:91], v[102:103], v[102:103], v[90:91]
    v_pk_add_f32 v[84:85], v[84:85], v[104:105]
    v_pk_fma_f32 v[92:93], v[104:105], v[104:105], v[92:93]
    v_pk_add_f32 v[86:87], v[86:87], v[106:107]
    v_pk_fma_f32 v[94:95], v[106:107], v[106:107], v[94:95]
    s_waitcnt vmcnt(6)
    v_lshlrev_b32 v100, 16, v44
    v_and_b32 v101, 0xffff0000, v44
    v_lshlrev_b32_e64 v102, 16, v45
    v_and_b32 v103, 0xffff0000, v45
    v_lshlrev_b32_e64 v104, 16, v46
    v_and_b32 v105, 0xffff0000, v46
    v_lshlrev_b32_e64 v106, 16, v47
    v_and_b32 v107, 0xffff0000, v47
    v_pk_add_f32 v[80:81], v[80:81], v[100:101]
    v_pk_fma_f32 v[88:89], v[100:101], v[100:101], v[88:89]
    v_pk_add_f32 v[82:83], v[82:83], v[102:103]
    v_pk_fma_f32 v[90:91], v[102:103], v[102:103], v[90:91]
    v_pk_add_f32 v[84:85], v[84:85], v[104:105]
    v_pk_fma_f32 v[92:93], v[104:105], v[104:105], v[92:93]
    v_pk_add_f32 v[86:87], v[86:87], v[106:107]
    v_pk_fma_f32 v[94:95], v[106:107], v[106:107], v[94:95]
    s_waitcnt vmcnt(5)
    v_lshlrev_b32 v100, 16, v48
    v_and_b32 v101, 0xffff0000, v48
    v_lshlrev_b32_e64 v102, 16, v49
    v_and_b32 v103, 0xffff0000, v49
    v_lshlrev_b32_e64 v104, 16, v50
    v_and_b32 v105, 0xffff0000, v50
    v_lshlrev_b32_e64 v106, 16, v51
    v_and_b32 v107, 0xffff0000, v51
    v_pk_add_f32 v[80:81], v[80:81], v[100:101]
    v_pk_fma_f32 v[88:89], v[100:101], v[100:101], v[88:89]
    v_pk_add_f32 v[82:83], v[82:83], v[102:103]
    v_pk_fma_f32 v[90:91], v[102:103], v[102:103], v[90:91]
    v_pk_add_f32 v[84:85], v[84:85], v[104:105]
    v_pk_fma_f32 v[92:93], v[104:105], v[104:105], v[92:93]
    v_pk_add_f32 v[86:87], v[86:87], v[106:107]
    v_pk_fma_f32 v[94:95], v[106:107], v[106:107], v[94:95]
    s_waitcnt vmcnt(4)
    v_lshlrev_b32 v100, 16, v52
    v_and_b32 v101, 0xffff0000, v52
    v_lshlrev_b32_e64 v102, 16, v53
    v_and_b32 v103, 0xffff0000, v53
    v_lshlrev_b32_e64 v104, 16, v54
    v_and_b32 v105, 0xffff0000, v54
    v_lshlrev_b32_e64 v106, 16, v55
    v_and_b32 v107, 0xffff0000, v55
    v_pk_add_f32 v[80:81], v[80:81], v[100:101]
    v_pk_fma_f32 v[88:89], v[100:101], v[100:101], v[88:89]
    v_pk_add_f32 v[82:83], v[82:83], v[102:103]
    v_pk_fma_f32 v[90:91], v[102:103], v[102:103], v[90:91]
    v_pk_add_f32 v[84:85], v[84:85], v[104:105]
    v_pk_fma_f32 v[92:93], v[104:105], v[104:105], v[92:93]
    v_pk_add_f32 v[86:87], v[86:87], v[106:107]
    v_pk_fma_f32 v[94:95], v[106:107], v[106:107], v[94:95]
    s_waitcnt vmcnt(3)
    v_lshlrev_b32 v100, 16, v56
    v_and_b32 v101, 0xffff0000, v56
    v_lshlrev_b32_e64 v102, 16, v57
    v_and_b32 v103, 0xffff0000, v57
    v_lshlrev_b32_e64 v104, 16, v58
    v_and_b32 v105, 0xffff0000, v58
    v_lshlrev_b32_e64 v106, 16, v59
    v_and_b32 v107, 0xffff0000, v59
    v_pk_add_f32 v[80:81], v[80:81], v[100:101]
    v_pk_fma_f32 v[88:89], v[100:101], v[100:101], v[88:89]
    v_pk_add_f32 v[82:83], v[82:83], v[102:103]
    v_pk_fma_f32 v[90:91], v[102:103], v[102:103], v[90:91]
    v_pk_add_f32 v[84:85], v[84:85], v[104:105]
    v_pk_fma_f32 v[92:93], v[104:105], v[104:105], v[92:93]
    v_pk_add_f32 v[86:87], v[86:87], v[106:107]
    v_pk_fma_f32 v[94:95], v[106:107], v[106:107], v[94:95]
    s_waitcnt vmcnt(2)
    v_lshlrev_b32 v100, 16, v60
    v_and_b32 v101, 0xffff0000, v60
    v_lshlrev_b32_e64 v102, 16, v61
    v_and_b32 v103, 0xffff0000, v61
    v_lshlrev_b32_e64 v104, 16, v62
    v_and_b32 v105, 0xffff0000, v62
    v_lshlrev_b32_e64 v106, 16, v63
    v_and_b32 v107, 0xffff0000, v63
    v_pk_add_f32 v[80:81], v[80:81], v[100:101]
    v_pk_fma_f32 v[88:89], v[100:101], v[100:101], v[88:89]
    v_pk_add_f32 v[82:83], v[82:83], v[102:103]
    v_pk_fma_f32 v[90:91], v[102:103], v[102:103], v[90:91]
    v_pk_add_f32 v[84:85], v[84:85], v[104:105]
    v_pk_fma_f32 v[92:93], v[104:105], v[104:105], v[92:93]
    v_pk_add_f32 v[86:87], v[86:87], v[106:107]
    v_pk_fma_f32 v[94:95], v[106:107], v[106:107], v[94:95]
    s_waitcnt vmcnt(1)
    v_lshlrev_b32 v100, 16, v64
    v_and_b32 v101, 0xffff0000, v64
    v_lshlrev_b32_e64 v102, 16, v65
    v_and_b32 v103, 0xffff0000, v65
    v_lshlrev_b32_e64 v104, 16, v66
    v_and_b32 v105, 0xffff0000, v66
    v_lshlrev_b32_e64 v106, 16, v67
    v_and_b32 v107, 0xffff0000, v67
    v_pk_add_f32 v[80:81], v[80:81], v[100:101]
    v_pk_fma_f32 v[88:89], v[100:101], v[100:101], v[88:89]
    v_pk_add_f32 v[82:83], v[82:83], v[102:103]
    v_pk_fma_f32 v[90:91], v[102:103], v[102:103], v[90:91]
    v_pk_add_f32 v[84:85], v[84:85], v[104:105]
    v_pk_fma_f32 v[92:93], v[104:105], v[104:105], v[92:93]
    v_pk_add_f32 v[86:87], v[86:87], v[106:107]
    v_pk_fma_f32 v[94:95], v[106:107], v[106:107], v[94:95]
    s_waitcnt vmcnt(0)
    v_lshlrev_b32 v100, 16, v68
    v_and_b32 v101, 0xffff0000, v68
    v_lshlrev_b32_e64 v102, 16, v69
    v_and_b32 v103, 0xffff0000, v69
    v_lshlrev_b32_e64 v104, 16, v70
    v_and_b32 v105, 0xffff0000, v70
    v_lshlrev_b32_e64 v106, 16, v71
    v_and_b32 v107, 0xffff0000, v71
    v_pk_add_f32 v[80:81], v[80:81], v[100:101]
    v_pk_fma_f32 v[88:89], v[100:101], v[100:101], v[88:89]
    v_pk_add_f32 v[82:83], v[82:83], v[102:103]
    v_pk_fma_f32 v[90:91], v[102:103], v[102:103], v[90:91]
    v_pk_add_f32 v[84:85], v[84:85], v[104:105]
    v_pk_fma_f32 v[92:93], v[104:105], v[104:105], v[92:93]
    v_pk_add_f32 v[86:87], v[86:87], v[106:107]
    v_pk_fma_f32 v[94:95], v[106:107], v[106:107], v[94:95]
    v_add_f32_dpp v80, v80, v80 row_ror:8 row_mask:0xf bank_mask:0xf
    v_add_f32_dpp v81, v81, v81 row_ror:8 row_mask:0xf bank_mask:0xf
    v_add_f32_dpp v82, v82, v82 row_ror:8 row_mask:0xf bank_mask:0xf
    v_add_f32_dpp v83, v83, v83 row_ror:8 row_mask:0xf bank_mask:0xf
    v_add_f32_dpp v84, v84, v84 row_ror:8 row_mask:0xf bank_mask:0xf
    v_add_f32_dpp v85, v85, v85 row_ror:8 row_mask:0xf bank_mask:0xf
    v_add_f32_dpp v86, v86, v86 row_ror:8 row_mask:0xf bank_mask:0xf
    v_add_f32_dpp v87, v87, v87 row_ror:8 row_mask:0xf bank_mask:0xf
    v_add_f32_dpp v88, v88, v88 row_ror:8 row_mask:0xf bank_mask:0xf
    v_add_f32_dpp v89, v89, v89 row_ror:8 row_mask:0xf bank_mask:0xf
    v_add_f32_dpp v90, v90, v90 row_ror:8 row_mask:0xf bank_mask:0xf
    v_add_f32_dpp v91, v91, v91 row_ror:8 row_mask:0xf bank_mask:0xf
    v_add_f32_dpp v92, v92, v92 row_ror:8 row_mask:0xf bank_mask:0xf
    v_add_f32_dpp v93, v93, v93 row_ror:8 row_mask:0xf bank_mask:0xf
    v_add_f32_dpp v94, v94, v94 row_ror:8 row_mask:0xf bank_mask:0xf
    v_add_f32_dpp v95, v95, v95 row_ror:8 row_mask:0xf bank_mask:0xf
    v_mov_b32 v100, v80
    v_mov_b32 v101, v81
    v_mov_b32 v102, v82
    v_mov_b32 v103, v83
    v_mov_b32 v104, v84
    v_mov_b32 v105, v85
    v_mov_b32 v106, v86
    v_mov_b32 v107, v87
    v_mov_b32 v108, v88
    v_mov_b32 v109, v89
    v_mov_b32 v110, v90
    v_mov_b32 v111, v91
    v_mov_b32 v112, v92
    v_mov_b32 v113, v93
    v_mov_b32 v114, v94
    v_mov_b32 v115, v95
    v_permlane16_swap_b32 v80, v100
    v_permlane16_swap_b32 v81, v101
    v_permlane16_swap_b32 v82, v102
    v_permlane16_swap_b32 v83, v103
    v_permlane16_swap_b32 v84, v104
    v_permlane16_swap_b32 v85, v105
    v_permlane16_swap_b32 v86, v106
    v_permlane16_swap_b32 v87, v107
    v_permlane16_swap_b32 v88, v108
    v_permlane16_swap_b32 v89, v109
    v_permlane16_swap_b32 v90, v110
    v_permlane16_swap_b32 v91, v111
    v_permlane16_swap_b32 v92, v112
    v_permlane16_swap_b32 v93, v113
    v_permlane16_swap_b32 v94, v114
    v_permlane16_swap_b32 v95, v115
    v_add_f32 v80, v80, v100
    v_mov_b32 v100, v80
    v_add_f32 v81, v81, v101
    v_mov_b32 v101, v81
    v_add_f32 v82, v82, v102
    v_mov_b32 v102, v82
    v_add_f32 v83, v83, v103
    v_mov_b32 v103, v83
    v_add_f32 v84, v84, v104
    v_mov_b32 v104, v84
    v_add_f32 v85, v85, v105
    v_mov_b32 v105, v85
    v_add_f32 v86, v86, v106
    v_mov_b32 v106, v86
    v_add_f32 v87, v87, v107
    v_mov_b32 v107, v87
    v_add_f32 v88, v88, v108
    v_mov_b32 v108, v88
    v_add_f32 v89, v89, v109
    v_mov_b32 v109, v89
    v_add_f32 v90, v90, v110
    v_mov_b32 v110, v90
    v_add_f32 v91, v91, v111
    v_mov_b32 v111, v91
    v_add_f32 v92, v92, v112
    v_mov_b32 v112, v92
    v_add_f32 v93, v93, v113
    v_mov_b32 v113, v93
    v_add_f32 v94, v94, v114
    v_mov_b32 v114, v94
    v_add_f32 v95, v95, v115
    v_mov_b32 v115, v95
    v_permlane32_swap_b32 v80, v100
    v_permlane32_swap_b32 v81, v101
    v_permlane32_swap_b32 v82, v102
    v_permlane32_swap_b32 v83, v103
    v_permlane32_swap_b32 v84, v104
    v_permlane32_swap_b32 v85, v105
    v_permlane32_swap_b32 v86, v106
    v_permlane32_swap_b32 v87, v107
    v_permlane32_swap_b32 v88, v108
    v_permlane32_swap_b32 v89, v109
    v_permlane32_swap_b32 v90, v110
    v_permlane32_swap_b32 v91, v111
    v_permlane32_swap_b32 v92, v112
    v_permlane32_swap_b32 v93, v113
    v_permlane32_swap_b32 v94, v114
    v_permlane32_swap_b32 v95, v115
    v_add_f32 v80, v80, v100
    v_add_f32 v81, v81, v101
    v_add_f32 v82, v82, v102
    v_add_f32 v83, v83, v103
    v_add_f32 v84, v84, v104
    v_add_f32 v85, v85, v105
    v_add_f32 v86, v86, v106
    v_add_f32 v87, v87, v107
    v_add_f32 v88, v88, v108
    v_add_f32 v89, v89, v109
    v_add_f32 v90, v90, v110
    v_add_f32 v91, v91, v111
    v_add_f32 v92, v92, v112
    v_add_f32 v93, v93, v113
    v_add_f32 v94, v94, v114
    v_add_f32 v95, v95, v115
    v_and_b32 v5, 7, v1
    v_lshlrev_b32 v5, 5, v5
    s_lshl_b32 s54, s3, 9
    v_add_u32 v5, s54, v5
    s_mov_b32 exec_lo, 0xff
    s_mov_b32 exec_hi, 0
    ds_write_b128 v5, v[80:83] offset:0
    ds_write_b128 v5, v[84:87] offset:16
    ds_write_b128 v5, v[88:91] offset:256
    ds_write_b128 v5, v[92:95] offset:272
    s_mov_b64 exec, -1
    s_waitcnt lgkmcnt(0)
    s_barrier
    s_cmp_lg_u32 s3, 0
    s_cbranch_scc1 sequential_preLN__ssm_conv_s4d__glu_gated_swiglu__prompt_kernel_hs266
    v_lshlrev_b32_e64 v6, 2, v1
    ds_read_b32 v16, v6 offset:0
    ds_read_b32 v17, v6 offset:256
    ds_read_b32 v18, v6 offset:512
    ds_read_b32 v19, v6 offset:768
    ds_read_b32 v20, v6 offset:1024
    ds_read_b32 v21, v6 offset:1280
    ds_read_b32 v22, v6 offset:1536
    ds_read_b32 v23, v6 offset:1792
    s_waitcnt lgkmcnt(5)
    v_add_f32 v16, v16, v18
    s_waitcnt lgkmcnt(1)
    v_add_f32 v20, v20, v22
    v_add_f32 v16, v16, v20
    v_add_f32 v17, v17, v19
    s_waitcnt lgkmcnt(0)
    v_add_f32 v21, v21, v23
    v_add_f32_e64 v17, v17, v21
    v_mul_f32 v16, 0x3b124925, v16
    v_mul_f32 v17, 0x3b124925, v17
    v_fma_f32 v17, -v16, v16, v17
    v_cvt_pk_bf16_f32 v18, v16, v17
    v_lshlrev_b32_e64 v20, 16, v18
    v_and_b32 v21, 0xffff0000, v18
    v_add_f32 v21, 0x3727c5ac, v21
    v_cvt_pk_bf16_f32 v21, v21, v21
    v_and_b32 v21, 0xffff0000, v21
    v_sqrt_f32 v21, v21
    s_nop 0
    v_cvt_pk_bf16_f32 v21, v21, v21
    v_and_b32 v21, 0xffff0000, v21
    v_lshlrev_b32 v6, 3, v1
    s_lshl_b32 s54, s53, 9
    s_add_u32 s54, s54, 17678336
    buffer_store_dwordx2 v[20:21], v6, s[32:35], s54 offen sc1
    s_waitcnt vmcnt(0)
    s_lshl_b32 s54, s53, 6
    s_add_u32 s54, s54, 17674240
    v_mov_b32 v4, s54
    v_mov_b32 v5, 1
    s_mov_b64 exec, 1
    global_atomic_add v4, v5, s[30:31]
    s_mov_b64 exec, -1
sequential_preLN__ssm_conv_s4d__glu_gated_swiglu__prompt_kernel_hs266:
    s_cmp_lg_u32 s2, 255
    s_cbranch_scc1 sequential_preLN__ssm_conv_s4d__glu_gated_swiglu__prompt_kernel_nu67
    v_mov_b32 v4, 17874944
    v_mov_b32 v5, s71
    s_mov_b64 exec, 1
    global_store_dword v4, v5, s[30:31] sc1
    s_mov_b64 exec, -1
sequential_preLN__ssm_conv_s4d__glu_gated_swiglu__prompt_kernel_nu67:
sequential_preLN__ssm_conv_s4d__glu_gated_swiglu__prompt_kernel_done:
    s_endpgm
sequential_preLN__ssm_conv_s4d__glu_gated_swiglu__prompt_kernel_end:
.section .rodata,"a"
.p2align 6
.amdhsa_kernel sequential_preLN__ssm_conv_s4d__glu_gated_swiglu__prompt_kernel
  .amdhsa_next_free_vgpr 512
  .amdhsa_next_free_sgpr 102
  .amdhsa_accum_offset 256
  .amdhsa_group_segment_fixed_size 0
  .amdhsa_kernarg_size 112
  .amdhsa_user_sgpr_count 2
  .amdhsa_user_sgpr_kernarg_segment_ptr 1
  .amdhsa_system_sgpr_workgroup_id_x 1
.end_amdhsa_kernel
```
